```python
import torch

def _softmax(x, axis=-1):
    return torch.softmax(x, dim=axis)
def _gelu(x):
    return torch.nn.functional.gelu(x, approximate="tanh")
def _silu(x):
    return torch.nn.functional.silu(x)
def _sigmoid(x):
    return torch.sigmoid(x)
def _layernorm(x, axis=-1, eps=1e-5):
    m = x.mean(dim=axis, keepdim=True)
    v = x.var(dim=axis, keepdim=True, unbiased=False)
    return (x - m) / torch.sqrt(v + eps)
def _scatter_add(tgt, idx, src, axis=0):
    return tgt.clone().index_add_(axis, idx, src)
def _segment_sum(src, seg, n):
    out = torch.zeros((n,) + src.shape[1:], dtype=src.dtype)
    return out.index_add_(0, seg, src)
def _pad(x, pw):
    flat = tuple(v for pair in reversed(pw) for v in pair)
    return torch.nn.functional.pad(x, flat)

kernel_name = 'parallel_sum__grouped_kv_mqa__glu_gated_bilinear__prompt'

def setup_inputs():

    _w = (lambda a: (lambda t: t.to(torch.bfloat16) if t.is_floating_point() else t)(torch.as_tensor(a)))
    def _A_setup():
        B, S, D, H = 1, 2048, 640, 32
        Dh = D // H
        return {
            "x": _w((lambda *s: torch.randn(*s, dtype=torch.bfloat16) * 0.05)(B, S, D)),
            "wq": _w((lambda *s: torch.randn(*s, dtype=torch.bfloat16) * 0.05)(D, H * Dh)),
            "wk": _w((lambda *s: torch.randn(*s, dtype=torch.bfloat16) * 0.05)(D, Dh)),
            "wv": _w((lambda *s: torch.randn(*s, dtype=torch.bfloat16) * 0.05)(D, Dh)),
            "wo": _w((lambda *s: torch.randn(*s, dtype=torch.bfloat16) * 0.05)(H * Dh, D)),
        }
    _A_in = _A_setup()

    def _B_setup():
        B, S, D, F = 1, 2048, 640, 1536
        return {
            "x": _w((lambda *s: torch.randn(*s, dtype=torch.bfloat16) * 0.05)(B, S, D)),
            "w_gate": _w((lambda *s: torch.randn(*s, dtype=torch.bfloat16) * 0.8)(D, F) * (D ** -0.5)),
            "w_up": _w((lambda *s: torch.randn(*s, dtype=torch.bfloat16) * 0.8)(D, F) * (D ** -0.5)),
            "w_down": _w((lambda *s: torch.randn(*s, dtype=torch.bfloat16) * 0.8)(F, D) * (F ** -0.5)),
        }
    _B_in = _B_setup()

    return {
        "A_x": _A_in["x"],
        "A_wq": _A_in["wq"],
        "A_wk": _A_in["wk"],
        "A_wv": _A_in["wv"],
        "A_wo": _A_in["wo"],
        "B_x": _B_in["x"],
        "B_w_gate": _B_in["w_gate"],
        "B_w_up": _B_in["w_up"],
        "B_w_down": _B_in["w_down"],
    }

def reference(A_x, A_wq, A_wk, A_wv, A_wo, B_x, B_w_gate, B_w_up, B_w_down):
    def _A_ref(x, wq, wk, wv, wo):
        B, S, D = x.shape
        H = 32
        Dh = D // H
        q = (lambda x, *d: x.permute(*d))((x @ wq).reshape(B, S, H, Dh), 0, 2, 1, 3)
        k = x @ wk
        v = x @ wv
        scores = torch.einsum("bhqd,bkd->bhqk", q, k) * (Dh ** -0.5)
        p = _softmax(scores, axis=-1)
        o = torch.einsum("bhqk,bkd->bhqd", p, v)
        return (lambda x, *d: x.permute(*d))(o, 0, 2, 1, 3).reshape(B, S, H * Dh) @ wo

    def _B_ref(x, w_gate, w_up, w_down):
        g = torch.einsum("bsd,df->bsf", x, w_gate)
        u = torch.einsum("bsd,df->bsf", x, w_up)
        h = g * u
        return torch.einsum("bsf,fd->bsd", h, w_down)

    x = A_x
    xn = _layernorm(x, axis=-1)
    return x + _A_ref(xn, A_wq, A_wk, A_wv, A_wo) + _B_ref(xn, B_w_gate, B_w_up, B_w_down)
```

```asm
; @launch grid=(256,1,1) block=(512,1,1) lds=163840
.amdgcn_target "amdgcn-amd-amdhsa--gfx950"
.text
.globl parallel_sum__grouped_kv_mqa__glu_gated_bilinear__prompt_kernel
.p2align 8
.type parallel_sum__grouped_kv_mqa__glu_gated_bilinear__prompt_kernel,@function
parallel_sum__grouped_kv_mqa__glu_gated_bilinear__prompt_kernel:
    s_cmp_ge_u32 s2, 256
    s_cbranch_scc1 L_end
    s_load_dwordx16 s[64:79], s[0:1], 0
    s_load_dwordx8 s[80:87], s[0:1], 64
    v_lshrrev_b32 v3, 6, v0
    v_and_b32 v1, 63, v0
    v_readfirstlane_b32 s6, v3
    v_lshlrev_b32 v2, 4, v1
    v_mov_b32 v5, 0
    s_bfe_u32 s4, s2, 0x10002
    s_lshl_b32 s4, s4, 4
    s_lshr_b32 s7, s2, 4
    s_add_u32 s4, s4, s7
    s_and_b32 s5, s2, 3
    s_lshl_b32 s5, s5, 1
    s_bfe_u32 s7, s2, 0x10003
    s_add_u32 s5, s5, s7
    s_and_b32 s3, s6, 3
    v_lshlrev_b32 v7, 2, v1
    s_cmp_lg_u32 s6, 0
    s_cbranch_scc1 L_nozero
    ds_write_b32 v7, v5
L_nozero:
    s_waitcnt lgkmcnt(0)
    s_mov_b32 s8, s64
    s_mov_b32 s9, s65
    s_mov_b32 s10, 2621440
    s_mov_b32 s11, 0x00020000
    s_mov_b32 s88, s84
    s_mov_b32 s89, s85
    s_mov_b32 s90, 256
    s_mov_b32 s91, 0x00020000
    s_cmp_ge_u32 s6, 4
    s_cbranch_scc1 L_g_role
    s_cmp_ge_u32 s3, s5
    s_addc_u32 s24, s3, 0
    s_lshl_b32 s7, s4, 3
    s_add_u32 s7, s7, s24
    s_mul_i32 s7, s7, 10240
    v_lshrrev_b32 v4, 3, v1
    v_mul_u32_u24 v10, 1280, v4
    v_and_b32 v3, 7, v1
    v_lshl_add_u32 v10, v3, 4, v10
    v_mul_u32_u24 v11, 528, v3
    v_lshl_add_u32 v11, v4, 4, v11
    s_and_b32 s63, s24, 3
    s_lshl_b32 s63, s63, 7
    s_lshr_b32 s24, s24, 2
    s_mul_i32 s24, s24, 42240
    s_add_u32 s24, s24, s63
    s_add_u32 s24, s24, 256
    v_add_u32 v11, s24, v11
    s_or_b32 s25, s2, s6
    s_cmp_lg_u32 s25, 0
    s_cbranch_scc1 L_notagpub
    s_memrealtime s[60:61]
    s_waitcnt lgkmcnt(0)
    s_or_b32 s60, s60, 1
    v_mov_b32 v8, s60
    s_mov_b64 exec, 1
    buffer_store_dword v8, v5, s[88:91], 0 offen sc1
    s_mov_b64 exec, -1
L_notagpub:
    buffer_load_dwordx4 v[16:19], v10, s[8:11], s7 offen offset:0
    buffer_load_dwordx4 v[20:23], v10, s[8:11], s7 offen offset:128
    buffer_load_dwordx4 v[24:27], v10, s[8:11], s7 offen offset:256
    buffer_load_dwordx4 v[28:31], v10, s[8:11], s7 offen offset:384
    buffer_load_dwordx4 v[32:35], v10, s[8:11], s7 offen offset:512
    buffer_load_dwordx4 v[36:39], v10, s[8:11], s7 offen offset:640
    buffer_load_dwordx4 v[40:43], v10, s[8:11], s7 offen offset:768
    buffer_load_dwordx4 v[44:47], v10, s[8:11], s7 offen offset:896
    buffer_load_dwordx4 v[48:51], v10, s[8:11], s7 offen offset:1024
    buffer_load_dwordx4 v[52:55], v10, s[8:11], s7 offen offset:1152
    s_barrier
    s_setprio 3
    s_branch L_a_role
L_g_role:
    s_setprio 1
    v_lshrrev_b32 v3, 5, v1
    v_mul_u32_u24 v3, 1280, v3
    v_and_b32 v4, 31, v1
    v_lshl_add_u32 v56, v4, 4, v3
    v_mov_b32 v9, 1073741824
    v_cmp_gt_u32 vcc, 16, v4
    s_lshl_b32 s28, s4, 3
    s_add_u32 s28, s28, s5
    v_cndmask_b32 v57, v9, v56, vcc
    s_lshl_b32 s7, s28, 2
    s_add_u32 s7, s7, s3
    s_mul_i32 s7, s7, 2560
    s_mov_b64 s[60:61], vcc
    buffer_load_dwordx4 v[16:19], v56, s[8:11], s7 offen
    buffer_load_dwordx4 v[20:23], v56, s[8:11], s7 offen offset:512
    buffer_load_dwordx4 v[24:27], v57, s[8:11], s7 offen offset:1024
    s_barrier
    s_cmp_ge_u32 s3, 2
    s_cselect_b32 s12, s70, s68
    s_cselect_b32 s13, s71, s69
    s_mov_b32 s14, 25600
    s_mov_b32 s15, 0x00020000
    s_cselect_b32 s24, 26624, 0
    s_add_u32 s24, s24, 110592
    s_and_b32 s25, s3, 1
    s_lshl_b32 s25, s25, 10
    s_add_u32 s24, s24, s25
    s_add_u32 m0, s24, 0
    s_nop 0
    buffer_load_dwordx4 v2, s[12:15], s25 offen lds
    s_add_u32 s25, s25, 2048
    s_add_u32 m0, s24, 2048
    s_nop 0
    buffer_load_dwordx4 v2, s[12:15], s25 offen lds
    s_add_u32 s25, s25, 2048
    s_add_u32 m0, s24, 4096
    s_nop 0
    buffer_load_dwordx4 v2, s[12:15], s25 offen lds
    s_add_u32 s25, s25, 2048
    s_add_u32 m0, s24, 6144
    s_nop 0
    buffer_load_dwordx4 v2, s[12:15], s25 offen lds
    s_add_u32 s25, s25, 2048
    s_add_u32 m0, s24, 8192
    s_nop 0
    buffer_load_dwordx4 v2, s[12:15], s25 offen lds
    s_add_u32 s25, s25, 2048
    s_add_u32 m0, s24, 10240
    s_nop 0
    buffer_load_dwordx4 v2, s[12:15], s25 offen lds
    s_add_u32 s25, s25, 2048
    s_add_u32 m0, s24, 12288
    s_nop 0
    buffer_load_dwordx4 v2, s[12:15], s25 offen lds
    s_add_u32 s25, s25, 2048
    s_add_u32 m0, s24, 14336
    s_nop 0
    buffer_load_dwordx4 v2, s[12:15], s25 offen lds
    s_add_u32 s25, s25, 2048
    s_add_u32 m0, s24, 16384
    s_nop 0
    buffer_load_dwordx4 v2, s[12:15], s25 offen lds
    s_add_u32 s25, s25, 2048
    s_add_u32 m0, s24, 18432
    s_nop 0
    buffer_load_dwordx4 v2, s[12:15], s25 offen lds
    s_add_u32 s25, s25, 2048
    s_add_u32 m0, s24, 20480
    s_nop 0
    buffer_load_dwordx4 v2, s[12:15], s25 offen lds
    s_add_u32 s25, s25, 2048
    s_add_u32 m0, s24, 22528
    s_nop 0
    buffer_load_dwordx4 v2, s[12:15], s25 offen lds
    s_add_u32 s25, s25, 2048
    s_add_u32 m0, s24, 24576
    s_nop 0
    buffer_load_dwordx4 v2, s[12:15], s25 offen lds
    s_add_u32 s25, s25, 2048
    v_and_b32 v4, 31, v1
    v_and_b32 v3, 3, v1
    v_lshlrev_b32 v6, 2, v3
    v_add_u32 v6, 16, v6
    s_lshl_b32 s30, s3, 2
    s_add_u32 s30, s30, 16
    v_mov_b32 v7, s30
    v_lshrrev_b32 v58, 4, v1
    v_bfe_u32 v59, v1, 2, 2
    v_lshl_add_u32 v59, v58, 3, v59
    v_mul_u32_u24 v59, 40, v59
    v_lshlrev_b32 v3, 3, v3
    s_cmp_ge_u32 s3, 2
    s_cselect_b32 s24, 0, -1
    s_cselect_b32 s25, 32, 0
    s_bitcmp1_b32 s3, 0
    s_cselect_b32 s26, 26624, 0
    s_add_u32 s26, s26, 110592
    s_add_u32 s25, s25, s26
    v_and_b32 v3, s24, v3
    v_add3_u32 v59, v59, v3, s25
    s_lshr_b32 s26, s5, 2
    s_mul_i32 s26, s26, 42240
    s_and_b32 s27, s5, 3
    s_lshl_b32 s27, s27, 7
    s_add_u32 s26, s26, s27
    s_add_u32 s26, s26, 256
    v_and_b32 v3, 7, v1
    v_mul_u32_u24 v60, 528, v58
    v_lshl_add_u32 v60, v3, 4, v60
    v_add_u32 v60, s26, v60
    s_lshl_b32 s27, s3, 5
    s_add_u32 s27, s27, s26
    v_mul_u32_u24 v62, 528, v4
    v_lshrrev_b32 v3, 5, v1
    v_lshl_add_u32 v62, v3, 4, v62
    v_add_u32 v62, s27, v62
    s_add_u32 s24, s86, 2621440
    s_addc_u32 s25, s87, 0
    s_mov_b32 s26, 196608
    s_mov_b32 s27, 0x00020000
    s_add_u32 s56, s86, 2818048
    s_addc_u32 s57, s87, 0
    s_mov_b32 s58, 65536
    s_mov_b32 s59, 0x00020000
    s_mov_b32 s16, s76
    s_mov_b32 s17, s77
    s_mov_b32 s18, 1966080
    s_mov_b32 s19, 0x00020000
    s_mov_b32 s20, s78
    s_mov_b32 s21, s79
    s_mov_b32 s22, 1966080
    s_mov_b32 s23, 0x00020000
    s_lshr_b32 s29, s28, 2
    s_mul_i32 s29, s29, 3072
    s_bfe_u32 s30, s28, 0x10001
    s_and_b32 s31, s28, 1
    v_and_b32 v61, 15, v1
    s_bitcmp1_b32 s3, 0
    s_cbranch_scc1 L_g_va
    s_lshl_b32 s32, s30, 4
    s_lshl_b32 s33, s31, 2
    s_add_u32 s32, s32, s33
    v_lshrrev_b32 v30, 2, v61
    v_lshlrev_b32 v30, 3, v30
    v_and_b32 v28, 3, v61
    v_add3_u32 v30, v30, v28, s32
    v_lshrrev_b32 v28, 1, v58
    v_lshlrev_b32 v28, 9, v28
    v_lshl_add_u32 v28, v30, 4, v28
    v_and_b32 v31, 1, v58
    v_lshl_add_u32 v28, v31, 3, v28
    v_lshlrev_b32 v31, 3, v30
    v_lshl_add_u32 v31, v58, 8, v31
    v_add_u32 v31, 1024, v31
    v_cmp_gt_u32 vcc, 2, v58
    v_mov_b32 v29, 0x3f803f80
    v_mov_b32 v57, 0
    v_cndmask_b32 v31, v9, v31, vcc
    v_cmp_eq_u32 s[40:41], 1, v58
    s_cmp_ge_u32 s3, 2
    s_cselect_b64 vcc, -1, 0
    s_cselect_b64 s[40:41], s[40:41], 0
    v_cndmask_b32 v28, v28, v31, vcc
    v_cmp_gt_u32 vcc, 8, v61
    s_nop 1
    v_cndmask_b32 v28, v9, v28, vcc
    s_branch L_g_vb
L_g_va:
    s_mul_i32 s32, s30, 768
    s_mul_i32 s33, s31, 384
    s_add_u32 s32, s32, s33
    s_add_u32 s32, s32, 1536
    v_and_b32 v30, 3, v61
    v_bfe_u32 v28, v61, 2, 1
    v_lshl_add_u32 v30, v28, 3, v30
    v_bfe_u32 v28, v61, 3, 1
    v_lshl_add_u32 v30, v28, 2, v30
    v_add_u32 v28, 16, v61
    s_cmp_ge_u32 s3, 2
    s_cselect_b64 vcc, -1, 0
    s_cselect_b32 s33, 6, 16
    s_cselect_b32 s34, 4, 99
    s_cselect_b32 s35, 5, 99
    v_cndmask_b32 v30, v30, v28, vcc
    v_lshlrev_b32 v30, 4, v30
    v_lshl_add_u32 v30, v58, 3, v30
    v_add_u32 v30, s32, v30
    v_cmp_gt_u32 vcc, s33, v61
    v_mov_b32 v29, 0x3f803f80
    s_nop 0
    v_cndmask_b32 v30, v9, v30, vcc
    v_cmp_gt_u32 vcc, 2, v58
    s_nop 1
    v_cndmask_b32 v28, v9, v30, vcc
    v_cmp_eq_u32 s[40:41], s35, v61
    v_cmp_eq_u32 vcc, s34, v61
    s_nop 1
    v_cndmask_b32 v29, v29, v5, s[40:41]
    s_or_b64 s[40:41], vcc, s[40:41]
    v_mov_b32 v57, v29
L_g_vb:
    v_add_u32 v3, 0, v1
    v_mul_u32_u24 v4, 205, v3
    v_lshrrev_b32 v4, 11, v4
    v_mul_u32_u24 v144, 10, v4
    v_sub_u32 v3, v3, v144
    v_lshlrev_b32 v3, 4, v3
    v_mul_u32_u24 v144, 1280, v4
    v_add_u32 v144, v144, v3
    v_add_u32 v3, 64, v1
    v_mul_u32_u24 v4, 205, v3
    v_lshrrev_b32 v4, 11, v4
    v_mul_u32_u24 v145, 10, v4
    v_sub_u32 v3, v3, v145
    v_lshlrev_b32 v3, 4, v3
    v_subrev_u32 v3, 1024, v3
    v_mul_u32_u24 v145, 1280, v4
    v_add_u32 v145, v145, v3
    v_add_u32 v3, 128, v1
    v_mul_u32_u24 v4, 205, v3
    v_lshrrev_b32 v4, 11, v4
    v_mul_u32_u24 v146, 10, v4
    v_sub_u32 v3, v3, v146
    v_lshlrev_b32 v3, 4, v3
    v_subrev_u32 v3, 2048, v3
    v_mul_u32_u24 v146, 1280, v4
    v_add_u32 v146, v146, v3
    v_add_u32 v3, 192, v1
    v_mul_u32_u24 v4, 205, v3
    v_lshrrev_b32 v4, 11, v4
    v_mul_u32_u24 v147, 10, v4
    v_sub_u32 v3, v3, v147
    v_lshlrev_b32 v3, 4, v3
    v_subrev_u32 v3, 3072, v3
    v_mul_u32_u24 v147, 1280, v4
    v_add_u32 v147, v147, v3
    v_add_u32 v3, 256, v1
    v_mul_u32_u24 v4, 205, v3
    v_lshrrev_b32 v4, 11, v4
    v_mul_u32_u24 v148, 10, v4
    v_sub_u32 v3, v3, v148
    v_lshlrev_b32 v3, 4, v3
    v_mul_u32_u24 v148, 1280, v4
    v_add_u32 v148, v148, v3
    s_mov_b32 s92, s66
    s_mov_b32 s93, s67
    s_mov_b32 s94, 819200
    s_mov_b32 s95, 0x00020000
    s_mul_i32 s42, s5, 160
    s_mul_i32 s43, s3, 40960
    s_add_u32 s42, s42, s43
    s_mul_i32 s43, s3, 5120
    s_add_u32 s43, s43, 84736
    s_waitcnt vmcnt(15)
    buffer_load_dword v11, v5, s[88:91], 0 offen sc1
    v_lshlrev_b32 v32, 16, v16
    v_and_b32 v33, 0xffff0000, v16
    v_lshlrev_b32 v34, 16, v17
    v_and_b32 v35, 0xffff0000, v17
    v_lshlrev_b32 v36, 16, v18
    v_and_b32 v37, 0xffff0000, v18
    v_lshlrev_b32 v38, 16, v19
    v_and_b32 v39, 0xffff0000, v19
    v_pk_mul_f32 v[14:15], v[32:33], v[32:33]
    v_pk_add_f32 v[12:13], v[32:33], v[34:35]
    v_pk_fma_f32 v[14:15], v[34:35], v[34:35], v[14:15]
    v_pk_add_f32 v[12:13], v[12:13], v[36:37]
    v_pk_fma_f32 v[14:15], v[36:37], v[36:37], v[14:15]
    v_pk_add_f32 v[12:13], v[12:13], v[38:39]
    v_pk_fma_f32 v[14:15], v[38:39], v[38:39], v[14:15]
    s_waitcnt vmcnt(15)
    v_lshlrev_b32 v40, 16, v20
    v_and_b32 v41, 0xffff0000, v20
    v_lshlrev_b32 v42, 16, v21
    v_and_b32 v43, 0xffff0000, v21
    v_lshlrev_b32 v44, 16, v22
    v_and_b32 v45, 0xffff0000, v22
    v_lshlrev_b32 v46, 16, v23
    v_and_b32 v47, 0xffff0000, v23
    v_pk_add_f32 v[12:13], v[12:13], v[40:41]
    v_pk_fma_f32 v[14:15], v[40:41], v[40:41], v[14:15]
    v_pk_add_f32 v[12:13], v[12:13], v[42:43]
    v_pk_fma_f32 v[14:15], v[42:43], v[42:43], v[14:15]
    v_pk_add_f32 v[12:13], v[12:13], v[44:45]
    v_pk_fma_f32 v[14:15], v[44:45], v[44:45], v[14:15]
    v_pk_add_f32 v[12:13], v[12:13], v[46:47]
    v_pk_fma_f32 v[14:15], v[46:47], v[46:47], v[14:15]
    s_waitcnt vmcnt(14)
    v_lshlrev_b32 v48, 16, v24
    v_and_b32 v49, 0xffff0000, v24
    v_lshlrev_b32 v50, 16, v25
    v_and_b32 v51, 0xffff0000, v25
    v_lshlrev_b32 v52, 16, v26
    v_and_b32 v53, 0xffff0000, v26
    v_lshlrev_b32 v54, 16, v27
    v_and_b32 v55, 0xffff0000, v27
    v_pk_add_f32 v[12:13], v[12:13], v[48:49]
    v_pk_fma_f32 v[14:15], v[48:49], v[48:49], v[14:15]
    v_pk_add_f32 v[12:13], v[12:13], v[50:51]
    v_pk_fma_f32 v[14:15], v[50:51], v[50:51], v[14:15]
    v_pk_add_f32 v[12:13], v[12:13], v[52:53]
    v_pk_fma_f32 v[14:15], v[52:53], v[52:53], v[14:15]
    v_pk_add_f32 v[12:13], v[12:13], v[54:55]
    v_pk_fma_f32 v[14:15], v[54:55], v[54:55], v[14:15]
    v_add_f32 v12, v12, v13
    v_add_f32 v14, v14, v15
    s_nop 0
    v_add_f32_dpp v12, v12, v12 quad_perm:[1,0,3,2] row_mask:0xf bank_mask:0xf
    v_add_f32_dpp v14, v14, v14 quad_perm:[1,0,3,2] row_mask:0xf bank_mask:0xf
    s_nop 0
    v_add_f32_dpp v12, v12, v12 quad_perm:[2,3,0,1] row_mask:0xf bank_mask:0xf
    v_add_f32_dpp v14, v14, v14 quad_perm:[2,3,0,1] row_mask:0xf bank_mask:0xf
    s_nop 0
    v_add_f32_dpp v12, v12, v12 row_half_mirror row_mask:0xf bank_mask:0xf
    v_add_f32_dpp v14, v14, v14 row_half_mirror row_mask:0xf bank_mask:0xf
    s_nop 0
    v_add_f32_dpp v12, v12, v12 row_mirror row_mask:0xf bank_mask:0xf
    v_add_f32_dpp v14, v14, v14 row_mirror row_mask:0xf bank_mask:0xf
    s_nop 0
    v_mov_b32 v13, v12
    v_mov_b32 v15, v14
    s_nop 1
    v_permlane16_swap_b32 v12, v13
    v_permlane16_swap_b32 v14, v15
    s_nop 1
    v_add_f32 v12, v12, v13
    v_add_f32 v14, v14, v15
    v_mul_f32 v12, 0x3acccccd, v12
    v_mul_f32 v14, 0x3acccccd, v14
    v_fma_f32 v14, -v12, v12, v14
    v_max_f32 v14, 0, v14
    v_add_f32 v14, 0x3727c5ac, v14
    v_rsq_f32 v14, v14
    s_nop 0
    v_mul_f32 v12, v12, v14
    v_mov_b32 v15, v14
    v_sub_f32 v12, 0, v12
    v_mov_b32 v13, v12
    v_pk_fma_f32 v[32:33], v[32:33], v[14:15], v[12:13]
    v_pk_fma_f32 v[34:35], v[34:35], v[14:15], v[12:13]
    v_pk_fma_f32 v[36:37], v[36:37], v[14:15], v[12:13]
    v_pk_fma_f32 v[38:39], v[38:39], v[14:15], v[12:13]
    v_cvt_pk_bf16_f32 v16, v32, v33
    v_cvt_pk_bf16_f32 v17, v34, v35
    v_cvt_pk_bf16_f32 v18, v36, v37
    v_cvt_pk_bf16_f32 v19, v38, v39
    ds_write_b128 v62, v[16:19] offset:0
    v_pk_fma_f32 v[40:41], v[40:41], v[14:15], v[12:13]
    v_pk_fma_f32 v[42:43], v[42:43], v[14:15], v[12:13]
    v_pk_fma_f32 v[44:45], v[44:45], v[14:15], v[12:13]
    v_pk_fma_f32 v[46:47], v[46:47], v[14:15], v[12:13]
    v_cvt_pk_bf16_f32 v20, v40, v41
    v_cvt_pk_bf16_f32 v21, v42, v43
    v_cvt_pk_bf16_f32 v22, v44, v45
    v_cvt_pk_bf16_f32 v23, v46, v47
    ds_write_b128 v62, v[20:23] offset:16896
    v_pk_fma_f32 v[48:49], v[48:49], v[14:15], v[12:13]
    v_pk_fma_f32 v[50:51], v[50:51], v[14:15], v[12:13]
    v_pk_fma_f32 v[52:53], v[52:53], v[14:15], v[12:13]
    v_pk_fma_f32 v[54:55], v[54:55], v[14:15], v[12:13]
    v_cvt_pk_bf16_f32 v24, v48, v49
    v_cvt_pk_bf16_f32 v25, v50, v51
    v_cvt_pk_bf16_f32 v26, v52, v53
    v_cvt_pk_bf16_f32 v27, v54, v55
    s_mov_b64 exec, s[60:61]
    ds_write_b128 v62, v[24:27] offset:33792
    s_mov_b64 exec, -1
    s_waitcnt vmcnt(1)
    s_mov_b64 exec, 1
    v_mov_b32 v8, 1
    ds_write_b32 v7, v8
    s_mov_b64 exec, -1
    ds_read_b32 v8, v6
    s_waitcnt lgkmcnt(0)
    v_cmp_gt_u32 vcc, 1, v8
    s_cmp_eq_u64 vcc, 0
    s_cbranch_scc0 L_psl_3
L_pok_1:
    ds_read_b64_tr_b16 v[150:151], v59 offset:0
    ds_read_b64_tr_b16 v[152:153], v59 offset:160
    ds_read_b64_tr_b16 v[154:155], v59 offset:1280
    ds_read_b64_tr_b16 v[156:157], v59 offset:1440
    ds_read_b64_tr_b16 v[158:159], v59 offset:2560
    ds_read_b64_tr_b16 v[160:161], v59 offset:2720
    ds_read_b64_tr_b16 v[162:163], v59 offset:3840
    ds_read_b64_tr_b16 v[164:165], v59 offset:4000
    ds_read_b64_tr_b16 v[166:167], v59 offset:5120
    ds_read_b64_tr_b16 v[168:169], v59 offset:5280
    ds_read_b64_tr_b16 v[170:171], v59 offset:6400
    ds_read_b64_tr_b16 v[172:173], v59 offset:6560
    ds_read_b64_tr_b16 v[174:175], v59 offset:7680
    ds_read_b64_tr_b16 v[176:177], v59 offset:7840
    ds_read_b64_tr_b16 v[178:179], v59 offset:8960
    ds_read_b64_tr_b16 v[180:181], v59 offset:9120
    ds_read_b64_tr_b16 v[182:183], v59 offset:10240
    ds_read_b64_tr_b16 v[184:185], v59 offset:10400
    ds_read_b64_tr_b16 v[186:187], v59 offset:11520
    ds_read_b64_tr_b16 v[188:189], v59 offset:11680
    ds_read_b64_tr_b16 v[190:191], v59 offset:12800
    ds_read_b64_tr_b16 v[192:193], v59 offset:12960
    ds_read_b64_tr_b16 v[194:195], v59 offset:14080
    ds_read_b64_tr_b16 v[196:197], v59 offset:14240
    ds_read_b64_tr_b16 v[198:199], v59 offset:15360
    ds_read_b64_tr_b16 v[200:201], v59 offset:15520
    ds_read_b64_tr_b16 v[202:203], v59 offset:16640
    ds_read_b64_tr_b16 v[204:205], v59 offset:16800
    ds_read_b64_tr_b16 v[206:207], v59 offset:17920
    ds_read_b64_tr_b16 v[208:209], v59 offset:18080
    ds_read_b64_tr_b16 v[210:211], v59 offset:19200
    ds_read_b64_tr_b16 v[212:213], v59 offset:19360
    ds_read_b64_tr_b16 v[214:215], v59 offset:20480
    ds_read_b64_tr_b16 v[216:217], v59 offset:20640
    ds_read_b64_tr_b16 v[218:219], v59 offset:21760
    ds_read_b64_tr_b16 v[220:221], v59 offset:21920
    ds_read_b64_tr_b16 v[222:223], v59 offset:23040
    ds_read_b64_tr_b16 v[224:225], v59 offset:23200
    ds_read_b64_tr_b16 v[226:227], v59 offset:24320
    ds_read_b64_tr_b16 v[228:229], v59 offset:24480
    s_mov_b64 exec, 1
    v_mov_b32 v8, 2
    ds_write_b32 v7, v8
    s_mov_b64 exec, -1
    ds_read_b128 v[64:67], v60 offset:0
    ds_read_b128 v[68:71], v60 offset:2112
    ds_read_b128 v[72:75], v60 offset:4224
    ds_read_b128 v[76:79], v60 offset:6336
    ds_read_b128 v[80:83], v60 offset:8448
    ds_read_b128 v[84:87], v60 offset:10560
    ds_read_b128 v[88:91], v60 offset:12672
    ds_read_b128 v[92:95], v60 offset:14784
    ds_read_b128 v[96:99], v60 offset:16896
    ds_read_b128 v[100:103], v60 offset:19008
    ds_read_b128 v[104:107], v60 offset:21120
    ds_read_b128 v[108:111], v60 offset:23232
    ds_read_b128 v[112:115], v60 offset:25344
    ds_read_b128 v[116:119], v60 offset:27456
    ds_read_b128 v[120:123], v60 offset:29568
    ds_read_b128 v[124:127], v60 offset:31680
    ds_read_b128 v[128:131], v60 offset:33792
    ds_read_b128 v[132:135], v60 offset:35904
    ds_read_b128 v[136:139], v60 offset:38016
    ds_read_b128 v[140:143], v60 offset:40128
    s_bitcmp1_b32 s3, 0
    s_cbranch_scc1 L_g_v
    s_waitcnt lgkmcnt(15)
    v_mfma_f32_16x16x32_bf16 v[16:19], v[150:153], v[64:67], 0
    v_mfma_f32_16x16x32_bf16 v[16:19], v[154:157], v[68:71], v[16:19]
    v_mfma_f32_16x16x32_bf16 v[16:19], v[158:161], v[72:75], v[16:19]
    v_mfma_f32_16x16x32_bf16 v[16:19], v[162:165], v[76:79], v[16:19]
    v_mfma_f32_16x16x32_bf16 v[16:19], v[166:169], v[80:83], v[16:19]
    s_waitcnt lgkmcnt(14)
    v_mfma_f32_16x16x32_bf16 v[16:19], v[170:173], v[84:87], v[16:19]
    s_waitcnt lgkmcnt(13)
    v_mfma_f32_16x16x32_bf16 v[16:19], v[174:177], v[88:91], v[16:19]
    s_waitcnt lgkmcnt(12)
    v_mfma_f32_16x16x32_bf16 v[16:19], v[178:181], v[92:95], v[16:19]
    s_waitcnt lgkmcnt(11)
    v_mfma_f32_16x16x32_bf16 v[16:19], v[182:185], v[96:99], v[16:19]
    s_waitcnt lgkmcnt(10)
    v_mfma_f32_16x16x32_bf16 v[16:19], v[186:189], v[100:103], v[16:19]
    s_waitcnt lgkmcnt(9)
    v_mfma_f32_16x16x32_bf16 v[16:19], v[190:193], v[104:107], v[16:19]
    s_waitcnt lgkmcnt(8)
    v_mfma_f32_16x16x32_bf16 v[16:19], v[194:197], v[108:111], v[16:19]
    s_waitcnt lgkmcnt(7)
    v_mfma_f32_16x16x32_bf16 v[16:19], v[198:201], v[112:115], v[16:19]
    s_waitcnt lgkmcnt(6)
    v_mfma_f32_16x16x32_bf16 v[16:19], v[202:205], v[116:119], v[16:19]
    s_waitcnt lgkmcnt(5)
    v_mfma_f32_16x16x32_bf16 v[16:19], v[206:209], v[120:123], v[16:19]
    s_waitcnt lgkmcnt(4)
    v_mfma_f32_16x16x32_bf16 v[16:19], v[210:213], v[124:127], v[16:19]
    s_waitcnt lgkmcnt(3)
    v_mfma_f32_16x16x32_bf16 v[16:19], v[214:217], v[128:131], v[16:19]
    s_waitcnt lgkmcnt(2)
    v_mfma_f32_16x16x32_bf16 v[16:19], v[218:221], v[132:135], v[16:19]
    s_waitcnt lgkmcnt(1)
    v_mfma_f32_16x16x32_bf16 v[16:19], v[222:225], v[136:139], v[16:19]
    s_waitcnt lgkmcnt(0)
    v_mfma_f32_16x16x32_bf16 v[16:19], v[226:229], v[140:143], v[16:19]
    s_branch L_g_kvst
L_g_v:
    s_waitcnt lgkmcnt(15)
    v_mfma_f32_16x16x32_bf16 v[16:19], v[64:67], v[150:153], 0
    v_mfma_f32_16x16x32_bf16 v[16:19], v[68:71], v[154:157], v[16:19]
    v_mfma_f32_16x16x32_bf16 v[16:19], v[72:75], v[158:161], v[16:19]
    v_mfma_f32_16x16x32_bf16 v[16:19], v[76:79], v[162:165], v[16:19]
    v_mfma_f32_16x16x32_bf16 v[16:19], v[80:83], v[166:169], v[16:19]
    s_waitcnt lgkmcnt(14)
    v_mfma_f32_16x16x32_bf16 v[16:19], v[84:87], v[170:173], v[16:19]
    s_waitcnt lgkmcnt(13)
    v_mfma_f32_16x16x32_bf16 v[16:19], v[88:91], v[174:177], v[16:19]
    s_waitcnt lgkmcnt(12)
    v_mfma_f32_16x16x32_bf16 v[16:19], v[92:95], v[178:181], v[16:19]
    s_waitcnt lgkmcnt(11)
    v_mfma_f32_16x16x32_bf16 v[16:19], v[96:99], v[182:185], v[16:19]
    s_waitcnt lgkmcnt(10)
    v_mfma_f32_16x16x32_bf16 v[16:19], v[100:103], v[186:189], v[16:19]
    s_waitcnt lgkmcnt(9)
    v_mfma_f32_16x16x32_bf16 v[16:19], v[104:107], v[190:193], v[16:19]
    s_waitcnt lgkmcnt(8)
    v_mfma_f32_16x16x32_bf16 v[16:19], v[108:111], v[194:197], v[16:19]
    s_waitcnt lgkmcnt(7)
    v_mfma_f32_16x16x32_bf16 v[16:19], v[112:115], v[198:201], v[16:19]
    s_waitcnt lgkmcnt(6)
    v_mfma_f32_16x16x32_bf16 v[16:19], v[116:119], v[202:205], v[16:19]
    s_waitcnt lgkmcnt(5)
    v_mfma_f32_16x16x32_bf16 v[16:19], v[120:123], v[206:209], v[16:19]
    s_waitcnt lgkmcnt(4)
    v_mfma_f32_16x16x32_bf16 v[16:19], v[124:127], v[210:213], v[16:19]
    s_waitcnt lgkmcnt(3)
    v_mfma_f32_16x16x32_bf16 v[16:19], v[128:131], v[214:217], v[16:19]
    s_waitcnt lgkmcnt(2)
    v_mfma_f32_16x16x32_bf16 v[16:19], v[132:135], v[218:221], v[16:19]
    s_waitcnt lgkmcnt(1)
    v_mfma_f32_16x16x32_bf16 v[16:19], v[136:139], v[222:225], v[16:19]
    s_waitcnt lgkmcnt(0)
    v_mfma_f32_16x16x32_bf16 v[16:19], v[140:143], v[226:229], v[16:19]
L_g_kvst:
    s_nop 7
    v_cvt_pk_bf16_f32 v24, v16, v17
    v_cvt_pk_bf16_f32 v25, v18, v19
    v_cndmask_b32 v24, v24, v29, s[40:41]
    v_cndmask_b32 v25, v25, v57, s[40:41]
    buffer_store_dwordx2 v[24:25], v28, s[24:27], s29 offen sc1
    ds_read_b32 v8, v6
    s_waitcnt lgkmcnt(0)
    v_cmp_gt_u32 vcc, 2, v8
    s_cmp_eq_u64 vcc, 0
    s_cbranch_scc0 L_psl_6
L_pok_4:
    s_cmp_ge_u32 s3, 2
    s_cbranch_scc1 L_g_no13
    s_add_u32 m0, s43, 66560
    s_add_u32 s60, s42, 532480
    buffer_load_dwordx4 v144, s[92:95], s60 offen offset:0 lds
    buffer_load_dwordx4 v145, s[92:95], s60 offen offset:1024 lds
    buffer_load_dwordx4 v146, s[92:95], s60 offen offset:2048 lds
    buffer_load_dwordx4 v147, s[92:95], s60 offen offset:3072 lds
    s_add_u32 m0, s43, 70656
    s_add_u32 s60, s42, 532480
    buffer_load_dwordx4 v148, s[92:95], s60 offen lds
L_g_no13:
    s_add_u32 m0, s43, 25600
    s_add_u32 s60, s42, 204800
    buffer_load_dwordx4 v144, s[92:95], s60 offen offset:0 lds
    buffer_load_dwordx4 v145, s[92:95], s60 offen offset:1024 lds
    buffer_load_dwordx4 v146, s[92:95], s60 offen offset:2048 lds
    buffer_load_dwordx4 v147, s[92:95], s60 offen offset:3072 lds
    s_add_u32 m0, s43, 29696
    s_add_u32 s60, s42, 204800
    buffer_load_dwordx4 v148, s[92:95], s60 offen lds
    s_add_u32 m0, s43, 46080
    s_add_u32 s60, s42, 368640
    buffer_load_dwordx4 v144, s[92:95], s60 offen offset:0 lds
    buffer_load_dwordx4 v145, s[92:95], s60 offen offset:1024 lds
    buffer_load_dwordx4 v146, s[92:95], s60 offen offset:2048 lds
    buffer_load_dwordx4 v147, s[92:95], s60 offen offset:3072 lds
    s_add_u32 m0, s43, 50176
    s_add_u32 s60, s42, 368640
    buffer_load_dwordx4 v148, s[92:95], s60 offen lds
    s_waitcnt vmcnt(10)
    s_mov_b32 s63, 16384
L_tlp_8:
    v_readfirstlane_b32 s62, v11
    s_cmp_lg_u32 s62, 0
    s_cbranch_scc1 L_tok_7
    s_sleep 4
    buffer_load_dword v11, v5, s[88:91], 0 offen sc1
    s_waitcnt vmcnt(0)
    s_sub_u32 s63, s63, 1
    s_cbranch_scc0 L_tlp_8
L_tok_7:
    v_mov_b32 v3, s62
    s_lshl_b32 s36, s28, 4
    s_mov_b64 exec, 1
    v_mov_b32 v8, 1
    ds_add_rtn_u32 v8, v5, v8 offset:32
    s_waitcnt lgkmcnt(0)
    v_cmp_eq_u32 vcc, 3, v8
    s_and_b64 exec, exec, vcc
    s_cbranch_execz L_g_nokvflag
    buffer_store_dword v3, v5, s[56:59], s36 offen sc1
L_g_nokvflag:
    s_mov_b64 exec, -1
    v_subrev_u32 v4, 16, v6
    s_waitcnt vmcnt(1)
    s_cbranch_vccnz L_g_p2ok
    s_waitcnt vmcnt(0)
L_g_p2ok:
    s_mov_b64 exec, 1
    v_mov_b32 v8, 3
    ds_write_b32 v7, v8
    s_mov_b64 exec, -1
    ds_read_b32 v8, v4
    s_waitcnt lgkmcnt(0)
    v_cmp_gt_u32 vcc, 4, v8
    s_cmp_eq_u64 vcc, 0
    s_cbranch_scc0 L_psl_11
L_pok_9:
    s_cmp_lg_u32 s3, 0
    s_cbranch_scc1 L_g_no19
    s_add_u32 m0, s43, 20480
    s_add_u32 s60, s42, 778240
    buffer_load_dwordx4 v144, s[92:95], s60 offen offset:0 lds
    buffer_load_dwordx4 v145, s[92:95], s60 offen offset:1024 lds
    buffer_load_dwordx4 v146, s[92:95], s60 offen offset:2048 lds
    buffer_load_dwordx4 v147, s[92:95], s60 offen offset:3072 lds
    s_add_u32 m0, s43, 24576
    s_add_u32 s60, s42, 778240
    buffer_load_dwordx4 v148, s[92:95], s60 offen lds
L_g_no19:
    s_add_u32 m0, s43, 0
    s_add_u32 s60, s42, 614400
    buffer_load_dwordx4 v144, s[92:95], s60 offen offset:0 lds
    buffer_load_dwordx4 v145, s[92:95], s60 offen offset:1024 lds
    buffer_load_dwordx4 v146, s[92:95], s60 offen offset:2048 lds
    buffer_load_dwordx4 v147, s[92:95], s60 offen offset:3072 lds
    s_add_u32 m0, s43, 4096
    s_add_u32 s60, s42, 614400
    buffer_load_dwordx4 v148, s[92:95], s60 offen lds
    v_add_u32 v12, 0, v1
    v_mul_u32_u24 v3, 171, v12
    v_lshrrev_b32 v3, 10, v3
    v_mul_u32_u24 v4, 6, v3
    v_sub_u32 v4, v12, v4
    v_mul_u32_u24 v3, 3072, v3
    v_lshl_add_u32 v12, v4, 4, v3
    v_add_u32 v13, 64, v1
    v_mul_u32_u24 v3, 171, v13
    v_lshrrev_b32 v3, 10, v3
    v_mul_u32_u24 v4, 6, v3
    v_sub_u32 v4, v13, v4
    v_mul_u32_u24 v3, 3072, v3
    v_lshl_add_u32 v13, v4, 4, v3
    v_subrev_u32 v13, 1024, v13
    v_add_u32 v14, 128, v1
    v_mul_u32_u24 v3, 171, v14
    v_lshrrev_b32 v3, 10, v3
    v_mul_u32_u24 v4, 6, v3
    v_sub_u32 v4, v14, v4
    v_mul_u32_u24 v3, 3072, v3
    v_lshl_add_u32 v14, v4, 4, v3
    v_subrev_u32 v14, 2048, v14
    s_mul_i32 s32, s5, 384
    s_mul_i32 s33, s3, 96
    s_add_u32 s32, s32, s33
    s_mul_i32 s33, s3, 6272
    s_add_u32 s33, s33, 84736
    s_waitcnt lgkmcnt(0)
    s_waitcnt vmcnt(0)
    s_mov_b64 exec, 1
    v_mov_b32 v8, 4
    ds_write_b32 v7, v8
    s_mov_b64 exec, -1
    s_and_b32 s60, s4, 15
    s_lshl_b32 s60, s60, 2
    s_add_u32 s60, s60, s3
    s_mul_i32 s60, s60, 30720
    s_mul_i32 s61, s5, 384
    s_add_u32 s60, s60, s61
    v_mul_u32_u24 v4, 171, v1
    v_lshrrev_b32 v4, 9, v4
    v_mul_u32_u24 v3, 3, v4
    v_sub_u32 v3, v1, v3
    v_lshlrev_b32 v3, 7, v3
    v_min_u32 v3, 380, v3
    v_min_u32 v4, 9, v4
    v_mul_u32_u24 v4, 3072, v4
    v_add_u32 v3, v3, v4
    buffer_load_dword v10, v3, s[16:19], s60 offen
    buffer_load_dword v10, v3, s[20:23], s60 offen
    v_subrev_u32 v11, 16, v6
    v_lshrrev_b32 v4, 5, v1
    v_bfe_u32 v15, v1, 2, 2
    v_lshl_add_u32 v15, v4, 3, v15
    v_mul_u32_u24 v229, 320, v15
    v_mul_u32_u24 v15, 96, v15
    v_mul_u32_u24 v9, 528, v4
    v_mul_u32_u24 v230, 40, v4
    v_and_b32 v4, 1, v1
    v_lshl_add_u32 v15, v4, 4, v15
    v_bfe_u32 v4, v1, 1, 1
    v_lshl_add_u32 v15, v4, 3, v15
    v_bfe_u32 v4, v1, 4, 1
    v_mul_u32_u24 v3, 3200, v4
    v_add3_u32 v15, v15, v3, s33
    v_and_b32 v3, 3, v1
    v_lshl_add_u32 v3, v4, 2, v3
    s_lshl_b32 s29, s3, 1
    v_add_u32 v3, s29, v3
    v_and_b32 v3, 7, v3
    v_mul_u32_u24 v3, 40, v3
    s_mov_b32 s29, s33
    v_add3_u32 v252, v229, v3, s29
    v_and_b32 v3, 7, v1
    v_lshlrev_b32 v253, 4, v3
    v_and_b32 v3, 31, v1
    v_lshl_add_u32 v9, v3, 4, v9
    v_add_u32 v9, 256, v9
    v_add_u32 v242, 42240, v9
    v_mul_u32_u24 v3, 1280, v3
    v_add_u32 v254, v230, v3
    v_add_u32 v3, 0, v1
    v_mul_u32_u24 v4, 205, v3
    v_lshrrev_b32 v4, 12, v4
    v_mul_u32_u24 v232, 20, v4
    v_sub_u32 v3, v3, v232
    v_lshlrev_b32 v3, 4, v3
    v_mul_u32_u24 v232, 1280, v4
    v_add_u32 v232, v232, v3
    v_lshrrev_b32 v4, 2, v4
    v_add_u32 v4, 1, v4
    v_mul_u32_u24 v4, 20480, v4
    v_add_u32 v237, v232, v4
    v_add_u32 v3, 64, v1
    v_mul_u32_u24 v4, 205, v3
    v_lshrrev_b32 v4, 12, v4
    v_mul_u32_u24 v233, 20, v4
    v_sub_u32 v3, v3, v233
    v_lshlrev_b32 v3, 4, v3
    v_subrev_u32 v3, 1024, v3
    v_mul_u32_u24 v233, 1280, v4
    v_add_u32 v233, v233, v3
    v_lshrrev_b32 v4, 2, v4
    v_add_u32 v4, 1, v4
    v_mul_u32_u24 v4, 20480, v4
    v_add_u32 v238, v233, v4
    v_add_u32 v3, 128, v1
    v_mul_u32_u24 v4, 205, v3
    v_lshrrev_b32 v4, 12, v4
    v_mul_u32_u24 v234, 20, v4
    v_sub_u32 v3, v3, v234
    v_lshlrev_b32 v3, 4, v3
    v_subrev_u32 v3, 2048, v3
    v_mul_u32_u24 v234, 1280, v4
    v_add_u32 v234, v234, v3
    v_lshrrev_b32 v4, 2, v4
    v_add_u32 v4, 1, v4
    v_mul_u32_u24 v4, 20480, v4
    v_add_u32 v239, v234, v4
    v_add_u32 v3, 192, v1
    v_mul_u32_u24 v4, 205, v3
    v_lshrrev_b32 v4, 12, v4
    v_mul_u32_u24 v235, 20, v4
    v_sub_u32 v3, v3, v235
    v_lshlrev_b32 v3, 4, v3
    v_subrev_u32 v3, 3072, v3
    v_mul_u32_u24 v235, 1280, v4
    v_add_u32 v235, v235, v3
    v_lshrrev_b32 v4, 2, v4
    v_add_u32 v4, 1, v4
    v_mul_u32_u24 v4, 20480, v4
    v_add_u32 v240, v235, v4
    v_add_u32 v3, 256, v1
    v_mul_u32_u24 v4, 205, v3
    v_lshrrev_b32 v4, 12, v4
    v_mul_u32_u24 v236, 20, v4
    v_sub_u32 v3, v3, v236
    v_lshlrev_b32 v3, 4, v3
    v_mul_u32_u24 v236, 1280, v4
    v_add_u32 v236, v236, v3
    v_lshrrev_b32 v4, 2, v4
    v_add_u32 v4, 1, v4
    v_mul_u32_u24 v4, 20480, v4
    v_add_u32 v241, v236, v4
    s_add_u32 s24, s86, 3145728
    s_addc_u32 s25, s87, 0
    s_mov_b32 s26, 6291456
    s_mov_b32 s27, 0x00020000
    s_mov_b32 s12, s86
    s_mov_b32 s13, s87
    s_mov_b32 s14, 2621440
    s_mov_b32 s15, 0x00020000
    s_mov_b32 s92, s80
    s_mov_b32 s93, s81
    s_mov_b32 s94, 1966080
    s_mov_b32 s95, 0x00020000
    s_mov_b32 s96, s72
    s_mov_b32 s97, s73
    s_mov_b32 s98, 819200
    s_mov_b32 s99, 0x00020000
    s_lshl_b32 s36, s4, 1
    s_mul_i32 s36, s36, 98304
    s_mul_i32 s37, s5, 12288
    s_mul_i32 s7, s3, 3072
    s_add_u32 s7, s7, s37
    s_add_u32 s36, s36, s7
    s_add_u32 s37, s36, 98304
    s_and_b32 s38, s5, 3
    ds_read_b32 v8, v11
    s_waitcnt lgkmcnt(0)
    v_cmp_gt_u32 vcc, 8, v8
    s_cmp_eq_u64 vcc, 0
    s_cbranch_scc0 L_psl_14
L_pok_12:
    s_setprio 0
    s_mul_i32 s38, s38, 320
    s_mul_i32 s39, s7, 20
    s_add_u32 s39, s39, s38
    s_mul_i32 s40, s3, 204800
    s_add_u32 s40, s40, s38
    s_mov_b32 s41, s40
    s_lshl_b32 s30, s4, 9
    s_lshl_b32 s31, s3, 7
    s_add_u32 s30, s30, s31
    s_lshl_b32 s42, s5, 4
    s_add_u32 s42, s42, s30
    s_add_u32 s42, s42, 16384
    s_add_u32 s30, s30, 16384
    v_mov_b32 v153, s62
    v_add_u32 v255, s29, v2
    s_add_u32 s34, s39, 40960
    s_add_u32 s34, s34, 204800
    s_sub_u32 s60, s34, 1966080
    s_cmp_ge_u32 s34, 1966080
    s_cselect_b32 s34, s60, s34
    s_add_u32 m0, s33, 0
    s_nop 0
    buffer_load_dwordx4 v12, s[16:19], s32 offen offset:0 lds
    buffer_load_dwordx4 v13, s[16:19], s32 offen offset:1024 lds
    buffer_load_dwordx4 v14, s[16:19], s32 offen offset:2048 lds
    s_add_u32 m0, s33, 3200
    s_nop 0
    buffer_load_dwordx4 v12, s[20:23], s32 offen offset:0 lds
    buffer_load_dwordx4 v13, s[20:23], s32 offen offset:1024 lds
    buffer_load_dwordx4 v14, s[20:23], s32 offen offset:2048 lds
    s_add_u32 s32, s32, 98304
    s_add_u32 m0, s33, 51200
    s_nop 0
    buffer_load_dwordx4 v12, s[16:19], s32 offen offset:0 lds
    buffer_load_dwordx4 v13, s[16:19], s32 offen offset:1024 lds
    buffer_load_dwordx4 v14, s[16:19], s32 offen offset:2048 lds
    s_add_u32 m0, s33, 54400
    s_nop 0
    buffer_load_dwordx4 v12, s[20:23], s32 offen offset:0 lds
    buffer_load_dwordx4 v13, s[20:23], s32 offen offset:1024 lds
    buffer_load_dwordx4 v14, s[20:23], s32 offen offset:2048 lds
    s_add_u32 s32, s32, 98304
    ds_read_b128 v[112:115], v9 offset:0
    s_waitcnt vmcnt(6)
    ds_read_b64_tr_b16 v[120:121], v15 offset:0
    ds_read_b64_tr_b16 v[122:123], v15 offset:384
    ds_read_b64_tr_b16 v[124:125], v15 offset:32
    ds_read_b64_tr_b16 v[126:127], v15 offset:416
    ds_read_b64_tr_b16 v[128:129], v15 offset:64
    ds_read_b64_tr_b16 v[130:131], v15 offset:448
    ds_read_b128 v[116:119], v242 offset:0
    s_waitcnt lgkmcnt(5)
    v_mfma_f32_32x32x16_bf16 v[16:31], v[120:123], v[112:115], 0
    ds_read_b128 v[132:135], v9 offset:1056
    ds_read_b64_tr_b16 v[140:141], v15 offset:1536
    s_waitcnt lgkmcnt(5)
    v_mfma_f32_32x32x16_bf16 v[32:47], v[124:127], v[112:115], 0
    ds_read_b64_tr_b16 v[142:143], v15 offset:1920
    ds_read_b64_tr_b16 v[144:145], v15 offset:1568
    s_waitcnt lgkmcnt(5)
    v_mfma_f32_32x32x16_bf16 v[48:63], v[128:131], v[112:115], 0
    ds_read_b64_tr_b16 v[146:147], v15 offset:1952
    s_waitcnt lgkmcnt(5)
    v_mfma_f32_32x32x16_bf16 v[64:79], v[120:123], v[116:119], 0
    ds_read_b64_tr_b16 v[148:149], v15 offset:1600
    v_mfma_f32_32x32x16_bf16 v[80:95], v[124:127], v[116:119], 0
    ds_read_b64_tr_b16 v[150:151], v15 offset:1984
    v_mfma_f32_32x32x16_bf16 v[96:111], v[128:131], v[116:119], 0
    ds_read_b128 v[136:139], v242 offset:1056
    s_waitcnt lgkmcnt(5)
    v_mfma_f32_32x32x16_bf16 v[16:31], v[140:143], v[132:135], v[16:31]
    ds_read_b128 v[112:115], v9 offset:2112
    s_waitcnt vmcnt(0)
    ds_read_b64_tr_b16 v[120:121], v15 offset:51200
    ds_read_b32 v8, v11
    s_waitcnt lgkmcnt(0)
    v_cmp_gt_u32 vcc, 10, v8
    s_cmp_eq_u64 vcc, 0
    s_cbranch_scc0 L_psl_17
L_pok_15:
    v_mfma_f32_32x32x16_bf16 v[32:47], v[144:147], v[132:135], v[32:47]
    ds_read_b64_tr_b16 v[122:123], v15 offset:51584
    ds_read_b64_tr_b16 v[124:125], v15 offset:51232
    v_mfma_f32_32x32x16_bf16 v[48:63], v[148:151], v[132:135], v[48:63]
    ds_read_b64_tr_b16 v[126:127], v15 offset:51616
    s_add_u32 m0, s33, 25600
    s_nop 0
    buffer_load_dwordx4 v12, s[16:19], s32 offen offset:0 lds
    v_mfma_f32_32x32x16_bf16 v[64:79], v[140:143], v[136:139], v[64:79]
    ds_read_b64_tr_b16 v[128:129], v15 offset:51264
    buffer_load_dwordx4 v13, s[16:19], s32 offen offset:1024 lds
    v_mfma_f32_32x32x16_bf16 v[80:95], v[144:147], v[136:139], v[80:95]
    ds_read_b64_tr_b16 v[130:131], v15 offset:51648
    buffer_load_dwordx4 v14, s[16:19], s32 offen offset:2048 lds
    v_mfma_f32_32x32x16_bf16 v[96:111], v[148:151], v[136:139], v[96:111]
    ds_read_b128 v[116:119], v242 offset:2112
    s_add_u32 m0, s33, 28800
    s_nop 0
    buffer_load_dwordx4 v12, s[20:23], s32 offen offset:0 lds
    s_waitcnt lgkmcnt(5)
    v_mfma_f32_32x32x16_bf16 v[16:31], v[120:123], v[112:115], v[16:31]
    ds_read_b128 v[132:135], v9 offset:3168
    ds_read_b64_tr_b16 v[140:141], v15 offset:52736
    buffer_load_dwordx4 v13, s[20:23], s32 offen offset:1024 lds
    s_waitcnt lgkmcnt(5)
    v_mfma_f32_32x32x16_bf16 v[32:47], v[124:127], v[112:115], v[32:47]
    ds_read_b64_tr_b16 v[142:143], v15 offset:53120
    ds_read_b64_tr_b16 v[144:145], v15 offset:52768
    buffer_load_dwordx4 v14, s[20:23], s32 offen offset:2048 lds
    s_add_u32 s32, s32, 98304
    s_waitcnt lgkmcnt(5)
    v_mfma_f32_32x32x16_bf16 v[48:63], v[128:131], v[112:115], v[48:63]
    ds_read_b64_tr_b16 v[146:147], v15 offset:53152
    s_add_u32 m0, s33, 0
    s_nop 0
    buffer_load_dwordx4 v12, s[16:19], s32 offen offset:0 lds
    s_waitcnt lgkmcnt(5)
    v_mfma_f32_32x32x16_bf16 v[64:79], v[120:123], v[116:119], v[64:79]
    ds_read_b64_tr_b16 v[148:149], v15 offset:52800
    buffer_load_dwordx4 v13, s[16:19], s32 offen offset:1024 lds
    v_mfma_f32_32x32x16_bf16 v[80:95], v[124:127], v[116:119], v[80:95]
    ds_read_b64_tr_b16 v[150:151], v15 offset:53184
    buffer_load_dwordx4 v14, s[16:19], s32 offen offset:2048 lds
    v_mfma_f32_32x32x16_bf16 v[96:111], v[128:131], v[116:119], v[96:111]
    ds_read_b128 v[136:139], v242 offset:3168
    s_add_u32 m0, s33, 3200
    s_nop 0
    buffer_load_dwordx4 v12, s[20:23], s32 offen offset:0 lds
    s_waitcnt lgkmcnt(5)
    v_mfma_f32_32x32x16_bf16 v[16:31], v[140:143], v[132:135], v[16:31]
    ds_read_b128 v[112:115], v9 offset:4224
    s_waitcnt vmcnt(4)
    ds_read_b64_tr_b16 v[120:121], v15 offset:25600
    s_waitcnt lgkmcnt(5)
    v_mfma_f32_32x32x16_bf16 v[32:47], v[144:147], v[132:135], v[32:47]
    ds_read_b64_tr_b16 v[122:123], v15 offset:25984
    ds_read_b64_tr_b16 v[124:125], v15 offset:25632
    s_waitcnt lgkmcnt(5)
    v_mfma_f32_32x32x16_bf16 v[48:63], v[148:151], v[132:135], v[48:63]
    ds_read_b64_tr_b16 v[126:127], v15 offset:26016
    buffer_load_dwordx4 v13, s[20:23], s32 offen offset:1024 lds
    s_waitcnt lgkmcnt(5)
    v_mfma_f32_32x32x16_bf16 v[64:79], v[140:143], v[136:139], v[64:79]
    ds_read_b64_tr_b16 v[128:129], v15 offset:25664
    buffer_load_dwordx4 v14, s[20:23], s32 offen offset:2048 lds
    s_add_u32 s32, s32, 98304
    v_mfma_f32_32x32x16_bf16 v[80:95], v[144:147], v[136:139], v[80:95]
    ds_read_b64_tr_b16 v[130:131], v15 offset:26048
    v_mfma_f32_32x32x16_bf16 v[96:111], v[148:151], v[136:139], v[96:111]
    ds_read_b128 v[116:119], v242 offset:4224
    s_waitcnt lgkmcnt(5)
    v_mfma_f32_32x32x16_bf16 v[16:31], v[120:123], v[112:115], v[16:31]
    ds_read_b128 v[132:135], v9 offset:5280
    ds_read_b64_tr_b16 v[140:141], v15 offset:27136
    s_waitcnt lgkmcnt(5)
    v_mfma_f32_32x32x16_bf16 v[32:47], v[124:127], v[112:115], v[32:47]
    ds_read_b64_tr_b16 v[142:143], v15 offset:27520
    ds_read_b64_tr_b16 v[144:145], v15 offset:27168
    s_waitcnt lgkmcnt(5)
    v_mfma_f32_32x32x16_bf16 v[48:63], v[128:131], v[112:115], v[48:63]
    ds_read_b64_tr_b16 v[146:147], v15 offset:27552
    s_add_u32 m0, s33, 51200
    s_nop 0
    buffer_load_dwordx4 v12, s[16:19], s32 offen offset:0 lds
    s_waitcnt lgkmcnt(5)
    v_mfma_f32_32x32x16_bf16 v[64:79], v[120:123], v[116:119], v[64:79]
    ds_read_b64_tr_b16 v[148:149], v15 offset:27200
    buffer_load_dwordx4 v13, s[16:19], s32 offen offset:1024 lds
    v_mfma_f32_32x32x16_bf16 v[80:95], v[124:127], v[116:119], v[80:95]
    ds_read_b64_tr_b16 v[150:151], v15 offset:27584
    buffer_load_dwordx4 v14, s[16:19], s32 offen offset:2048 lds
    v_mfma_f32_32x32x16_bf16 v[96:111], v[128:131], v[116:119], v[96:111]
    ds_read_b128 v[136:139], v242 offset:5280
    s_add_u32 m0, s33, 54400
    s_nop 0
    buffer_load_dwordx4 v12, s[20:23], s32 offen offset:0 lds
    s_waitcnt lgkmcnt(5)
    v_mfma_f32_32x32x16_bf16 v[16:31], v[140:143], v[132:135], v[16:31]
    ds_read_b128 v[112:115], v9 offset:6336
    s_waitcnt vmcnt(4)
    ds_read_b64_tr_b16 v[120:121], v15 offset:0
    s_waitcnt lgkmcnt(5)
    v_mfma_f32_32x32x16_bf16 v[32:47], v[144:147], v[132:135], v[32:47]
    ds_read_b64_tr_b16 v[122:123], v15 offset:384
    ds_read_b64_tr_b16 v[124:125], v15 offset:32
    s_waitcnt lgkmcnt(5)
    v_mfma_f32_32x32x16_bf16 v[48:63], v[148:151], v[132:135], v[48:63]
    ds_read_b64_tr_b16 v[126:127], v15 offset:416
    buffer_load_dwordx4 v13, s[20:23], s32 offen offset:1024 lds
    s_waitcnt lgkmcnt(5)
    v_mfma_f32_32x32x16_bf16 v[64:79], v[140:143], v[136:139], v[64:79]
    ds_read_b64_tr_b16 v[128:129], v15 offset:64
    buffer_load_dwordx4 v14, s[20:23], s32 offen offset:2048 lds
    s_add_u32 s32, s32, 98304
    v_mfma_f32_32x32x16_bf16 v[80:95], v[144:147], v[136:139], v[80:95]
    ds_read_b64_tr_b16 v[130:131], v15 offset:448
    v_mfma_f32_32x32x16_bf16 v[96:111], v[148:151], v[136:139], v[96:111]
    ds_read_b128 v[116:119], v242 offset:6336
    s_waitcnt lgkmcnt(5)
    v_mfma_f32_32x32x16_bf16 v[16:31], v[120:123], v[112:115], v[16:31]
    ds_read_b128 v[132:135], v9 offset:7392
    ds_read_b64_tr_b16 v[140:141], v15 offset:1536
    s_waitcnt lgkmcnt(5)
    v_mfma_f32_32x32x16_bf16 v[32:47], v[124:127], v[112:115], v[32:47]
    ds_read_b64_tr_b16 v[142:143], v15 offset:1920
    ds_read_b64_tr_b16 v[144:145], v15 offset:1568
    s_waitcnt lgkmcnt(5)
    v_mfma_f32_32x32x16_bf16 v[48:63], v[128:131], v[112:115], v[48:63]
    ds_read_b64_tr_b16 v[146:147], v15 offset:1952
    s_add_u32 m0, s33, 25600
    s_nop 0
    buffer_load_dwordx4 v12, s[16:19], s32 offen offset:0 lds
    s_waitcnt lgkmcnt(5)
    v_mfma_f32_32x32x16_bf16 v[64:79], v[120:123], v[116:119], v[64:79]
    ds_read_b64_tr_b16 v[148:149], v15 offset:1600
    buffer_load_dwordx4 v13, s[16:19], s32 offen offset:1024 lds
    v_mfma_f32_32x32x16_bf16 v[80:95], v[124:127], v[116:119], v[80:95]
    ds_read_b64_tr_b16 v[150:151], v15 offset:1984
    buffer_load_dwordx4 v14, s[16:19], s32 offen offset:2048 lds
    v_mfma_f32_32x32x16_bf16 v[96:111], v[128:131], v[116:119], v[96:111]
    ds_read_b128 v[136:139], v242 offset:7392
    s_add_u32 m0, s33, 28800
    s_nop 0
    buffer_load_dwordx4 v12, s[20:23], s32 offen offset:0 lds
    s_waitcnt lgkmcnt(5)
    v_mfma_f32_32x32x16_bf16 v[16:31], v[140:143], v[132:135], v[16:31]
    ds_read_b128 v[112:115], v9 offset:8448
    s_waitcnt vmcnt(4)
    ds_read_b64_tr_b16 v[120:121], v15 offset:51200
    s_waitcnt lgkmcnt(5)
    v_mfma_f32_32x32x16_bf16 v[32:47], v[144:147], v[132:135], v[32:47]
    ds_read_b64_tr_b16 v[122:123], v15 offset:51584
    ds_read_b64_tr_b16 v[124:125], v15 offset:51232
    s_waitcnt lgkmcnt(5)
    v_mfma_f32_32x32x16_bf16 v[48:63], v[148:151], v[132:135], v[48:63]
    ds_read_b64_tr_b16 v[126:127], v15 offset:51616
    buffer_load_dwordx4 v13, s[20:23], s32 offen offset:1024 lds
    s_waitcnt lgkmcnt(5)
    v_mfma_f32_32x32x16_bf16 v[64:79], v[140:143], v[136:139], v[64:79]
    ds_read_b64_tr_b16 v[128:129], v15 offset:51264
    buffer_load_dwordx4 v14, s[20:23], s32 offen offset:2048 lds
    s_add_u32 s32, s32, 98304
    v_mfma_f32_32x32x16_bf16 v[80:95], v[144:147], v[136:139], v[80:95]
    ds_read_b64_tr_b16 v[130:131], v15 offset:51648
    v_mfma_f32_32x32x16_bf16 v[96:111], v[148:151], v[136:139], v[96:111]
    ds_read_b128 v[116:119], v242 offset:8448
    s_waitcnt lgkmcnt(5)
    v_mfma_f32_32x32x16_bf16 v[16:31], v[120:123], v[112:115], v[16:31]
    ds_read_b128 v[132:135], v9 offset:9504
    ds_read_b64_tr_b16 v[140:141], v15 offset:52736
    s_waitcnt lgkmcnt(5)
    v_mfma_f32_32x32x16_bf16 v[32:47], v[124:127], v[112:115], v[32:47]
    ds_read_b64_tr_b16 v[142:143], v15 offset:53120
    ds_read_b64_tr_b16 v[144:145], v15 offset:52768
    s_waitcnt lgkmcnt(5)
    v_mfma_f32_32x32x16_bf16 v[48:63], v[128:131], v[112:115], v[48:63]
    ds_read_b64_tr_b16 v[146:147], v15 offset:53152
    s_add_u32 m0, s33, 0
    s_nop 0
    buffer_load_dwordx4 v12, s[16:19], s32 offen offset:0 lds
    s_waitcnt lgkmcnt(5)
    v_mfma_f32_32x32x16_bf16 v[64:79], v[120:123], v[116:119], v[64:79]
    ds_read_b64_tr_b16 v[148:149], v15 offset:52800
    buffer_load_dwordx4 v13, s[16:19], s32 offen offset:1024 lds
    v_mfma_f32_32x32x16_bf16 v[80:95], v[124:127], v[116:119], v[80:95]
    ds_read_b64_tr_b16 v[150:151], v15 offset:53184
    buffer_load_dwordx4 v14, s[16:19], s32 offen offset:2048 lds
    v_mfma_f32_32x32x16_bf16 v[96:111], v[128:131], v[116:119], v[96:111]
    ds_read_b128 v[136:139], v242 offset:9504
    s_add_u32 m0, s33, 3200
    s_nop 0
    buffer_load_dwordx4 v12, s[20:23], s32 offen offset:0 lds
    s_waitcnt lgkmcnt(5)
    v_mfma_f32_32x32x16_bf16 v[16:31], v[140:143], v[132:135], v[16:31]
    ds_read_b128 v[112:115], v9 offset:10560
    s_waitcnt vmcnt(4)
    ds_read_b64_tr_b16 v[120:121], v15 offset:25600
    s_waitcnt lgkmcnt(5)
    v_mfma_f32_32x32x16_bf16 v[32:47], v[144:147], v[132:135], v[32:47]
    ds_read_b64_tr_b16 v[122:123], v15 offset:25984
    ds_read_b64_tr_b16 v[124:125], v15 offset:25632
    s_waitcnt lgkmcnt(5)
    v_mfma_f32_32x32x16_bf16 v[48:63], v[148:151], v[132:135], v[48:63]
    ds_read_b64_tr_b16 v[126:127], v15 offset:26016
    buffer_load_dwordx4 v13, s[20:23], s32 offen offset:1024 lds
    s_waitcnt lgkmcnt(5)
    v_mfma_f32_32x32x16_bf16 v[64:79], v[140:143], v[136:139], v[64:79]
    ds_read_b64_tr_b16 v[128:129], v15 offset:25664
    buffer_load_dwordx4 v14, s[20:23], s32 offen offset:2048 lds
    s_add_u32 s32, s32, 98304
    v_mfma_f32_32x32x16_bf16 v[80:95], v[144:147], v[136:139], v[80:95]
    ds_read_b64_tr_b16 v[130:131], v15 offset:26048
    v_mfma_f32_32x32x16_bf16 v[96:111], v[148:151], v[136:139], v[96:111]
    ds_read_b128 v[116:119], v242 offset:10560
    s_waitcnt lgkmcnt(5)
    v_mfma_f32_32x32x16_bf16 v[16:31], v[120:123], v[112:115], v[16:31]
    ds_read_b128 v[132:135], v9 offset:11616
    ds_read_b64_tr_b16 v[140:141], v15 offset:27136
    s_waitcnt lgkmcnt(5)
    v_mfma_f32_32x32x16_bf16 v[32:47], v[124:127], v[112:115], v[32:47]
    ds_read_b64_tr_b16 v[142:143], v15 offset:27520
    ds_read_b64_tr_b16 v[144:145], v15 offset:27168
    s_waitcnt lgkmcnt(5)
    v_mfma_f32_32x32x16_bf16 v[48:63], v[128:131], v[112:115], v[48:63]
    ds_read_b64_tr_b16 v[146:147], v15 offset:27552
    s_add_u32 m0, s33, 51200
    s_nop 0
    buffer_load_dwordx4 v12, s[16:19], s32 offen offset:0 lds
    s_waitcnt lgkmcnt(5)
    v_mfma_f32_32x32x16_bf16 v[64:79], v[120:123], v[116:119], v[64:79]
    ds_read_b64_tr_b16 v[148:149], v15 offset:27200
    buffer_load_dwordx4 v13, s[16:19], s32 offen offset:1024 lds
    v_mfma_f32_32x32x16_bf16 v[80:95], v[124:127], v[116:119], v[80:95]
    ds_read_b64_tr_b16 v[150:151], v15 offset:27584
    buffer_load_dwordx4 v14, s[16:19], s32 offen offset:2048 lds
    v_mfma_f32_32x32x16_bf16 v[96:111], v[128:131], v[116:119], v[96:111]
    ds_read_b128 v[136:139], v242 offset:11616
    s_add_u32 m0, s33, 54400
    s_nop 0
    buffer_load_dwordx4 v12, s[20:23], s32 offen offset:0 lds
    s_waitcnt lgkmcnt(5)
    v_mfma_f32_32x32x16_bf16 v[16:31], v[140:143], v[132:135], v[16:31]
    ds_read_b128 v[112:115], v9 offset:12672
    s_waitcnt vmcnt(4)
    ds_read_b64_tr_b16 v[120:121], v15 offset:0
    s_waitcnt lgkmcnt(5)
    v_mfma_f32_32x32x16_bf16 v[32:47], v[144:147], v[132:135], v[32:47]
    ds_read_b64_tr_b16 v[122:123], v15 offset:384
    ds_read_b64_tr_b16 v[124:125], v15 offset:32
    s_waitcnt lgkmcnt(5)
    v_mfma_f32_32x32x16_bf16 v[48:63], v[148:151], v[132:135], v[48:63]
    ds_read_b64_tr_b16 v[126:127], v15 offset:416
    buffer_load_dwordx4 v13, s[20:23], s32 offen offset:1024 lds
    s_waitcnt lgkmcnt(5)
    v_mfma_f32_32x32x16_bf16 v[64:79], v[140:143], v[136:139], v[64:79]
    ds_read_b64_tr_b16 v[128:129], v15 offset:64
    buffer_load_dwordx4 v14, s[20:23], s32 offen offset:2048 lds
    s_add_u32 s32, s32, 98304
    v_mfma_f32_32x32x16_bf16 v[80:95], v[144:147], v[136:139], v[80:95]
    ds_read_b64_tr_b16 v[130:131], v15 offset:448
    v_mfma_f32_32x32x16_bf16 v[96:111], v[148:151], v[136:139], v[96:111]
    ds_read_b128 v[116:119], v242 offset:12672
    s_waitcnt lgkmcnt(5)
    v_mfma_f32_32x32x16_bf16 v[16:31], v[120:123], v[112:115], v[16:31]
    ds_read_b128 v[132:135], v9 offset:13728
    ds_read_b64_tr_b16 v[140:141], v15 offset:1536
    s_waitcnt lgkmcnt(5)
    v_mfma_f32_32x32x16_bf16 v[32:47], v[124:127], v[112:115], v[32:47]
    ds_read_b64_tr_b16 v[142:143], v15 offset:1920
    ds_read_b64_tr_b16 v[144:145], v15 offset:1568
    s_waitcnt lgkmcnt(5)
    v_mfma_f32_32x32x16_bf16 v[48:63], v[128:131], v[112:115], v[48:63]
    ds_read_b64_tr_b16 v[146:147], v15 offset:1952
    s_add_u32 m0, s33, 25600
    s_nop 0
    buffer_load_dwordx4 v12, s[16:19], s32 offen offset:0 lds
    s_waitcnt lgkmcnt(5)
    v_mfma_f32_32x32x16_bf16 v[64:79], v[120:123], v[116:119], v[64:79]
    ds_read_b64_tr_b16 v[148:149], v15 offset:1600
    buffer_load_dwordx4 v13, s[16:19], s32 offen offset:1024 lds
    v_mfma_f32_32x32x16_bf16 v[80:95], v[124:127], v[116:119], v[80:95]
    ds_read_b64_tr_b16 v[150:151], v15 offset:1984
    buffer_load_dwordx4 v14, s[16:19], s32 offen offset:2048 lds
    v_mfma_f32_32x32x16_bf16 v[96:111], v[128:131], v[116:119], v[96:111]
    ds_read_b128 v[136:139], v242 offset:13728
    s_add_u32 m0, s33, 28800
    s_nop 0
    buffer_load_dwordx4 v12, s[20:23], s32 offen offset:0 lds
    s_waitcnt lgkmcnt(5)
    v_mfma_f32_32x32x16_bf16 v[16:31], v[140:143], v[132:135], v[16:31]
    ds_read_b128 v[112:115], v9 offset:14784
    s_waitcnt vmcnt(4)
    ds_read_b64_tr_b16 v[120:121], v15 offset:51200
    s_waitcnt lgkmcnt(5)
    v_mfma_f32_32x32x16_bf16 v[32:47], v[144:147], v[132:135], v[32:47]
    ds_read_b64_tr_b16 v[122:123], v15 offset:51584
    ds_read_b64_tr_b16 v[124:125], v15 offset:51232
    s_waitcnt lgkmcnt(5)
    v_mfma_f32_32x32x16_bf16 v[48:63], v[148:151], v[132:135], v[48:63]
    ds_read_b64_tr_b16 v[126:127], v15 offset:51616
    buffer_load_dwordx4 v13, s[20:23], s32 offen offset:1024 lds
    s_waitcnt lgkmcnt(5)
    v_mfma_f32_32x32x16_bf16 v[64:79], v[140:143], v[136:139], v[64:79]
    ds_read_b64_tr_b16 v[128:129], v15 offset:51264
    buffer_load_dwordx4 v14, s[20:23], s32 offen offset:2048 lds
    s_add_u32 s32, s32, 98304
    v_mfma_f32_32x32x16_bf16 v[80:95], v[144:147], v[136:139], v[80:95]
    ds_read_b64_tr_b16 v[130:131], v15 offset:51648
    v_mfma_f32_32x32x16_bf16 v[96:111], v[148:151], v[136:139], v[96:111]
    ds_read_b128 v[116:119], v242 offset:14784
    s_waitcnt lgkmcnt(5)
    v_mfma_f32_32x32x16_bf16 v[16:31], v[120:123], v[112:115], v[16:31]
    ds_read_b128 v[132:135], v9 offset:15840
    ds_read_b64_tr_b16 v[140:141], v15 offset:52736
    s_waitcnt lgkmcnt(5)
    v_mfma_f32_32x32x16_bf16 v[32:47], v[124:127], v[112:115], v[32:47]
    ds_read_b64_tr_b16 v[142:143], v15 offset:53120
    ds_read_b64_tr_b16 v[144:145], v15 offset:52768
    s_waitcnt lgkmcnt(5)
    v_mfma_f32_32x32x16_bf16 v[48:63], v[128:131], v[112:115], v[48:63]
    ds_read_b64_tr_b16 v[146:147], v15 offset:53152
    s_add_u32 m0, s33, 0
    s_nop 0
    buffer_load_dwordx4 v12, s[16:19], s32 offen offset:0 lds
    s_waitcnt lgkmcnt(5)
    v_mfma_f32_32x32x16_bf16 v[64:79], v[120:123], v[116:119], v[64:79]
    ds_read_b64_tr_b16 v[148:149], v15 offset:52800
    buffer_load_dwordx4 v13, s[16:19], s32 offen offset:1024 lds
    v_mfma_f32_32x32x16_bf16 v[80:95], v[124:127], v[116:119], v[80:95]
    ds_read_b64_tr_b16 v[150:151], v15 offset:53184
    buffer_load_dwordx4 v14, s[16:19], s32 offen offset:2048 lds
    v_mfma_f32_32x32x16_bf16 v[96:111], v[128:131], v[116:119], v[96:111]
    ds_read_b128 v[136:139], v242 offset:15840
    s_add_u32 m0, s33, 3200
    s_nop 0
    buffer_load_dwordx4 v12, s[20:23], s32 offen offset:0 lds
    s_waitcnt lgkmcnt(5)
    v_mfma_f32_32x32x16_bf16 v[16:31], v[140:143], v[132:135], v[16:31]
    ds_read_b128 v[112:115], v9 offset:16896
    s_waitcnt vmcnt(4)
    ds_read_b64_tr_b16 v[120:121], v15 offset:25600
    s_waitcnt lgkmcnt(5)
    v_mfma_f32_32x32x16_bf16 v[32:47], v[144:147], v[132:135], v[32:47]
    ds_read_b64_tr_b16 v[122:123], v15 offset:25984
    ds_read_b64_tr_b16 v[124:125], v15 offset:25632
    s_waitcnt lgkmcnt(5)
    v_mfma_f32_32x32x16_bf16 v[48:63], v[148:151], v[132:135], v[48:63]
    ds_read_b64_tr_b16 v[126:127], v15 offset:26016
    buffer_load_dwordx4 v13, s[20:23], s32 offen offset:1024 lds
    s_waitcnt lgkmcnt(5)
    v_mfma_f32_32x32x16_bf16 v[64:79], v[140:143], v[136:139], v[64:79]
    ds_read_b64_tr_b16 v[128:129], v15 offset:25664
    buffer_load_dwordx4 v14, s[20:23], s32 offen offset:2048 lds
    s_add_u32 s32, s32, 98304
    v_mfma_f32_32x32x16_bf16 v[80:95], v[144:147], v[136:139], v[80:95]
    ds_read_b64_tr_b16 v[130:131], v15 offset:26048
    v_mfma_f32_32x32x16_bf16 v[96:111], v[148:151], v[136:139], v[96:111]
    ds_read_b128 v[116:119], v242 offset:16896
    s_waitcnt lgkmcnt(5)
    v_mfma_f32_32x32x16_bf16 v[16:31], v[120:123], v[112:115], v[16:31]
    ds_read_b128 v[132:135], v9 offset:17952
    ds_read_b64_tr_b16 v[140:141], v15 offset:27136
    s_waitcnt lgkmcnt(5)
    v_mfma_f32_32x32x16_bf16 v[32:47], v[124:127], v[112:115], v[32:47]
    ds_read_b64_tr_b16 v[142:143], v15 offset:27520
    ds_read_b64_tr_b16 v[144:145], v15 offset:27168
    s_waitcnt lgkmcnt(5)
    v_mfma_f32_32x32x16_bf16 v[48:63], v[128:131], v[112:115], v[48:63]
    ds_read_b64_tr_b16 v[146:147], v15 offset:27552
    s_add_u32 m0, s33, 51200
    s_nop 0
    buffer_load_dwordx4 v12, s[16:19], s32 offen offset:0 lds
    s_waitcnt lgkmcnt(5)
    v_mfma_f32_32x32x16_bf16 v[64:79], v[120:123], v[116:119], v[64:79]
    ds_read_b64_tr_b16 v[148:149], v15 offset:27200
    buffer_load_dwordx4 v13, s[16:19], s32 offen offset:1024 lds
    v_mfma_f32_32x32x16_bf16 v[80:95], v[124:127], v[116:119], v[80:95]
    ds_read_b64_tr_b16 v[150:151], v15 offset:27584
    buffer_load_dwordx4 v14, s[16:19], s32 offen offset:2048 lds
    v_mfma_f32_32x32x16_bf16 v[96:111], v[128:131], v[116:119], v[96:111]
    ds_read_b128 v[136:139], v242 offset:17952
    s_add_u32 m0, s33, 54400
    s_nop 0
    buffer_load_dwordx4 v12, s[20:23], s32 offen offset:0 lds
    s_waitcnt lgkmcnt(5)
    v_mfma_f32_32x32x16_bf16 v[16:31], v[140:143], v[132:135], v[16:31]
    ds_read_b128 v[112:115], v9 offset:19008
    s_waitcnt vmcnt(4)
    ds_read_b64_tr_b16 v[120:121], v15 offset:0
    s_waitcnt lgkmcnt(5)
    v_mfma_f32_32x32x16_bf16 v[32:47], v[144:147], v[132:135], v[32:47]
    ds_read_b64_tr_b16 v[122:123], v15 offset:384
    ds_read_b64_tr_b16 v[124:125], v15 offset:32
    s_waitcnt lgkmcnt(5)
    v_mfma_f32_32x32x16_bf16 v[48:63], v[148:151], v[132:135], v[48:63]
    ds_read_b64_tr_b16 v[126:127], v15 offset:416
    buffer_load_dwordx4 v13, s[20:23], s32 offen offset:1024 lds
    s_waitcnt lgkmcnt(5)
    v_mfma_f32_32x32x16_bf16 v[64:79], v[140:143], v[136:139], v[64:79]
    ds_read_b64_tr_b16 v[128:129], v15 offset:64
    buffer_load_dwordx4 v14, s[20:23], s32 offen offset:2048 lds
    s_add_u32 s32, s32, 98304
    v_mfma_f32_32x32x16_bf16 v[80:95], v[144:147], v[136:139], v[80:95]
    ds_read_b64_tr_b16 v[130:131], v15 offset:448
    v_mfma_f32_32x32x16_bf16 v[96:111], v[148:151], v[136:139], v[96:111]
    ds_read_b128 v[116:119], v242 offset:19008
    s_waitcnt lgkmcnt(5)
    v_mfma_f32_32x32x16_bf16 v[16:31], v[120:123], v[112:115], v[16:31]
    ds_read_b128 v[132:135], v9 offset:20064
    ds_read_b64_tr_b16 v[140:141], v15 offset:1536
    s_waitcnt lgkmcnt(5)
    v_mfma_f32_32x32x16_bf16 v[32:47], v[124:127], v[112:115], v[32:47]
    ds_read_b64_tr_b16 v[142:143], v15 offset:1920
    ds_read_b64_tr_b16 v[144:145], v15 offset:1568
    s_waitcnt lgkmcnt(5)
    v_mfma_f32_32x32x16_bf16 v[48:63], v[128:131], v[112:115], v[48:63]
    ds_read_b64_tr_b16 v[146:147], v15 offset:1952
    s_add_u32 m0, s33, 25600
    s_nop 0
    buffer_load_dwordx4 v12, s[16:19], s32 offen offset:0 lds
    s_waitcnt lgkmcnt(5)
    v_mfma_f32_32x32x16_bf16 v[64:79], v[120:123], v[116:119], v[64:79]
    ds_read_b64_tr_b16 v[148:149], v15 offset:1600
    buffer_load_dwordx4 v13, s[16:19], s32 offen offset:1024 lds
    v_mfma_f32_32x32x16_bf16 v[80:95], v[124:127], v[116:119], v[80:95]
    ds_read_b64_tr_b16 v[150:151], v15 offset:1984
    buffer_load_dwordx4 v14, s[16:19], s32 offen offset:2048 lds
    v_mfma_f32_32x32x16_bf16 v[96:111], v[128:131], v[116:119], v[96:111]
    ds_read_b128 v[136:139], v242 offset:20064
    s_add_u32 m0, s33, 28800
    s_nop 0
    buffer_load_dwordx4 v12, s[20:23], s32 offen offset:0 lds
    s_waitcnt lgkmcnt(5)
    v_mfma_f32_32x32x16_bf16 v[16:31], v[140:143], v[132:135], v[16:31]
    ds_read_b128 v[112:115], v9 offset:21120
    s_waitcnt vmcnt(4)
    ds_read_b64_tr_b16 v[120:121], v15 offset:51200
    s_waitcnt lgkmcnt(5)
    v_mfma_f32_32x32x16_bf16 v[32:47], v[144:147], v[132:135], v[32:47]
    ds_read_b64_tr_b16 v[122:123], v15 offset:51584
    ds_read_b64_tr_b16 v[124:125], v15 offset:51232
    s_waitcnt lgkmcnt(5)
    v_mfma_f32_32x32x16_bf16 v[48:63], v[148:151], v[132:135], v[48:63]
    ds_read_b64_tr_b16 v[126:127], v15 offset:51616
    buffer_load_dwordx4 v13, s[20:23], s32 offen offset:1024 lds
    s_waitcnt lgkmcnt(5)
    v_mfma_f32_32x32x16_bf16 v[64:79], v[140:143], v[136:139], v[64:79]
    ds_read_b64_tr_b16 v[128:129], v15 offset:51264
    buffer_load_dwordx4 v14, s[20:23], s32 offen offset:2048 lds
    s_add_u32 s32, s32, 98304
    v_mfma_f32_32x32x16_bf16 v[80:95], v[144:147], v[136:139], v[80:95]
    ds_read_b64_tr_b16 v[130:131], v15 offset:51648
    v_mfma_f32_32x32x16_bf16 v[96:111], v[148:151], v[136:139], v[96:111]
    ds_read_b128 v[116:119], v242 offset:21120
    s_waitcnt lgkmcnt(5)
    v_mfma_f32_32x32x16_bf16 v[16:31], v[120:123], v[112:115], v[16:31]
    ds_read_b128 v[132:135], v9 offset:22176
    ds_read_b64_tr_b16 v[140:141], v15 offset:52736
    s_waitcnt lgkmcnt(5)
    v_mfma_f32_32x32x16_bf16 v[32:47], v[124:127], v[112:115], v[32:47]
    ds_read_b64_tr_b16 v[142:143], v15 offset:53120
    ds_read_b64_tr_b16 v[144:145], v15 offset:52768
    s_waitcnt lgkmcnt(5)
    v_mfma_f32_32x32x16_bf16 v[48:63], v[128:131], v[112:115], v[48:63]
    ds_read_b64_tr_b16 v[146:147], v15 offset:53152
    s_add_u32 m0, s33, 0
    s_nop 0
    buffer_load_dwordx4 v12, s[16:19], s32 offen offset:0 lds
    s_waitcnt lgkmcnt(5)
    v_mfma_f32_32x32x16_bf16 v[64:79], v[120:123], v[116:119], v[64:79]
    ds_read_b64_tr_b16 v[148:149], v15 offset:52800
    buffer_load_dwordx4 v13, s[16:19], s32 offen offset:1024 lds
    v_mfma_f32_32x32x16_bf16 v[80:95], v[124:127], v[116:119], v[80:95]
    ds_read_b64_tr_b16 v[150:151], v15 offset:53184
    buffer_load_dwordx4 v14, s[16:19], s32 offen offset:2048 lds
    v_mfma_f32_32x32x16_bf16 v[96:111], v[128:131], v[116:119], v[96:111]
    ds_read_b128 v[136:139], v242 offset:22176
    s_add_u32 m0, s33, 3200
    s_nop 0
    buffer_load_dwordx4 v12, s[20:23], s32 offen offset:0 lds
    s_waitcnt lgkmcnt(5)
    v_mfma_f32_32x32x16_bf16 v[16:31], v[140:143], v[132:135], v[16:31]
    ds_read_b128 v[112:115], v9 offset:23232
    s_waitcnt vmcnt(4)
    ds_read_b64_tr_b16 v[120:121], v15 offset:25600
    s_waitcnt lgkmcnt(5)
    v_mfma_f32_32x32x16_bf16 v[32:47], v[144:147], v[132:135], v[32:47]
    ds_read_b64_tr_b16 v[122:123], v15 offset:25984
    ds_read_b64_tr_b16 v[124:125], v15 offset:25632
    s_waitcnt lgkmcnt(5)
    v_mfma_f32_32x32x16_bf16 v[48:63], v[148:151], v[132:135], v[48:63]
    ds_read_b64_tr_b16 v[126:127], v15 offset:26016
    buffer_load_dwordx4 v13, s[20:23], s32 offen offset:1024 lds
    s_waitcnt lgkmcnt(5)
    v_mfma_f32_32x32x16_bf16 v[64:79], v[140:143], v[136:139], v[64:79]
    ds_read_b64_tr_b16 v[128:129], v15 offset:25664
    buffer_load_dwordx4 v14, s[20:23], s32 offen offset:2048 lds
    s_add_u32 s32, s32, 98304
    v_mfma_f32_32x32x16_bf16 v[80:95], v[144:147], v[136:139], v[80:95]
    ds_read_b64_tr_b16 v[130:131], v15 offset:26048
    v_mfma_f32_32x32x16_bf16 v[96:111], v[148:151], v[136:139], v[96:111]
    ds_read_b128 v[116:119], v242 offset:23232
    s_waitcnt lgkmcnt(5)
    v_mfma_f32_32x32x16_bf16 v[16:31], v[120:123], v[112:115], v[16:31]
    ds_read_b128 v[132:135], v9 offset:24288
    ds_read_b64_tr_b16 v[140:141], v15 offset:27136
    s_waitcnt lgkmcnt(5)
    v_mfma_f32_32x32x16_bf16 v[32:47], v[124:127], v[112:115], v[32:47]
    ds_read_b64_tr_b16 v[142:143], v15 offset:27520
    ds_read_b64_tr_b16 v[144:145], v15 offset:27168
    s_waitcnt lgkmcnt(5)
    v_mfma_f32_32x32x16_bf16 v[48:63], v[128:131], v[112:115], v[48:63]
    ds_read_b64_tr_b16 v[146:147], v15 offset:27552
    s_add_u32 m0, s33, 51200
    s_nop 0
    buffer_load_dwordx4 v12, s[16:19], s32 offen offset:0 lds
    s_waitcnt lgkmcnt(5)
    v_mfma_f32_32x32x16_bf16 v[64:79], v[120:123], v[116:119], v[64:79]
    ds_read_b64_tr_b16 v[148:149], v15 offset:27200
    buffer_load_dwordx4 v13, s[16:19], s32 offen offset:1024 lds
    v_mfma_f32_32x32x16_bf16 v[80:95], v[124:127], v[116:119], v[80:95]
    ds_read_b64_tr_b16 v[150:151], v15 offset:27584
    buffer_load_dwordx4 v14, s[16:19], s32 offen offset:2048 lds
    v_mfma_f32_32x32x16_bf16 v[96:111], v[128:131], v[116:119], v[96:111]
    ds_read_b128 v[136:139], v242 offset:24288
    s_add_u32 m0, s33, 54400
    s_nop 0
    buffer_load_dwordx4 v12, s[20:23], s32 offen offset:0 lds
    s_waitcnt lgkmcnt(5)
    v_mfma_f32_32x32x16_bf16 v[16:31], v[140:143], v[132:135], v[16:31]
    ds_read_b128 v[112:115], v9 offset:25344
    s_waitcnt vmcnt(4)
    ds_read_b64_tr_b16 v[120:121], v15 offset:0
    s_waitcnt lgkmcnt(5)
    v_mfma_f32_32x32x16_bf16 v[32:47], v[144:147], v[132:135], v[32:47]
    ds_read_b64_tr_b16 v[122:123], v15 offset:384
    ds_read_b64_tr_b16 v[124:125], v15 offset:32
    s_waitcnt lgkmcnt(5)
    v_mfma_f32_32x32x16_bf16 v[48:63], v[148:151], v[132:135], v[48:63]
    ds_read_b64_tr_b16 v[126:127], v15 offset:416
    buffer_load_dwordx4 v13, s[20:23], s32 offen offset:1024 lds
    s_waitcnt lgkmcnt(5)
    v_mfma_f32_32x32x16_bf16 v[64:79], v[140:143], v[136:139], v[64:79]
    ds_read_b64_tr_b16 v[128:129], v15 offset:64
    buffer_load_dwordx4 v14, s[20:23], s32 offen offset:2048 lds
    s_add_u32 s32, s32, 98304
    v_mfma_f32_32x32x16_bf16 v[80:95], v[144:147], v[136:139], v[80:95]
    ds_read_b64_tr_b16 v[130:131], v15 offset:448
    v_mfma_f32_32x32x16_bf16 v[96:111], v[148:151], v[136:139], v[96:111]
    ds_read_b128 v[116:119], v242 offset:25344
    s_waitcnt lgkmcnt(5)
    v_mfma_f32_32x32x16_bf16 v[16:31], v[120:123], v[112:115], v[16:31]
    ds_read_b128 v[132:135], v9 offset:26400
    ds_read_b64_tr_b16 v[140:141], v15 offset:1536
    s_waitcnt lgkmcnt(5)
    v_mfma_f32_32x32x16_bf16 v[32:47], v[124:127], v[112:115], v[32:47]
    ds_read_b64_tr_b16 v[142:143], v15 offset:1920
    ds_read_b64_tr_b16 v[144:145], v15 offset:1568
    s_waitcnt lgkmcnt(5)
    v_mfma_f32_32x32x16_bf16 v[48:63], v[128:131], v[112:115], v[48:63]
    ds_read_b64_tr_b16 v[146:147], v15 offset:1952
    s_add_u32 m0, s33, 25600
    s_nop 0
    buffer_load_dwordx4 v12, s[16:19], s32 offen offset:0 lds
    s_waitcnt lgkmcnt(5)
    v_mfma_f32_32x32x16_bf16 v[64:79], v[120:123], v[116:119], v[64:79]
    ds_read_b64_tr_b16 v[148:149], v15 offset:1600
    buffer_load_dwordx4 v13, s[16:19], s32 offen offset:1024 lds
    v_mfma_f32_32x32x16_bf16 v[80:95], v[124:127], v[116:119], v[80:95]
    ds_read_b64_tr_b16 v[150:151], v15 offset:1984
    buffer_load_dwordx4 v14, s[16:19], s32 offen offset:2048 lds
    v_mfma_f32_32x32x16_bf16 v[96:111], v[128:131], v[116:119], v[96:111]
    ds_read_b128 v[136:139], v242 offset:26400
    s_add_u32 m0, s33, 28800
    s_nop 0
    buffer_load_dwordx4 v12, s[20:23], s32 offen offset:0 lds
    s_waitcnt lgkmcnt(5)
    v_mfma_f32_32x32x16_bf16 v[16:31], v[140:143], v[132:135], v[16:31]
    ds_read_b128 v[112:115], v9 offset:27456
    s_waitcnt vmcnt(4)
    ds_read_b64_tr_b16 v[120:121], v15 offset:51200
    s_waitcnt lgkmcnt(5)
    v_mfma_f32_32x32x16_bf16 v[32:47], v[144:147], v[132:135], v[32:47]
    ds_read_b64_tr_b16 v[122:123], v15 offset:51584
    ds_read_b64_tr_b16 v[124:125], v15 offset:51232
    s_waitcnt lgkmcnt(5)
    v_mfma_f32_32x32x16_bf16 v[48:63], v[148:151], v[132:135], v[48:63]
    ds_read_b64_tr_b16 v[126:127], v15 offset:51616
    buffer_load_dwordx4 v13, s[20:23], s32 offen offset:1024 lds
    s_waitcnt lgkmcnt(5)
    v_mfma_f32_32x32x16_bf16 v[64:79], v[140:143], v[136:139], v[64:79]
    ds_read_b64_tr_b16 v[128:129], v15 offset:51264
    buffer_load_dwordx4 v14, s[20:23], s32 offen offset:2048 lds
    s_add_u32 s32, s32, 98304
    v_mfma_f32_32x32x16_bf16 v[80:95], v[144:147], v[136:139], v[80:95]
    ds_read_b64_tr_b16 v[130:131], v15 offset:51648
    v_mfma_f32_32x32x16_bf16 v[96:111], v[148:151], v[136:139], v[96:111]
    ds_read_b128 v[116:119], v242 offset:27456
    s_waitcnt lgkmcnt(5)
    v_mfma_f32_32x32x16_bf16 v[16:31], v[120:123], v[112:115], v[16:31]
    ds_read_b128 v[132:135], v9 offset:28512
    ds_read_b64_tr_b16 v[140:141], v15 offset:52736
    s_waitcnt lgkmcnt(5)
    v_mfma_f32_32x32x16_bf16 v[32:47], v[124:127], v[112:115], v[32:47]
    ds_read_b64_tr_b16 v[142:143], v15 offset:53120
    ds_read_b64_tr_b16 v[144:145], v15 offset:52768
    s_waitcnt lgkmcnt(5)
    v_mfma_f32_32x32x16_bf16 v[48:63], v[128:131], v[112:115], v[48:63]
    ds_read_b64_tr_b16 v[146:147], v15 offset:53152
    s_add_u32 m0, s33, 0
    s_nop 0
    buffer_load_dwordx4 v12, s[16:19], s32 offen offset:0 lds
    s_waitcnt lgkmcnt(5)
    v_mfma_f32_32x32x16_bf16 v[64:79], v[120:123], v[116:119], v[64:79]
    ds_read_b64_tr_b16 v[148:149], v15 offset:52800
    buffer_load_dwordx4 v13, s[16:19], s32 offen offset:1024 lds
    v_mfma_f32_32x32x16_bf16 v[80:95], v[124:127], v[116:119], v[80:95]
    ds_read_b64_tr_b16 v[150:151], v15 offset:53184
    buffer_load_dwordx4 v14, s[16:19], s32 offen offset:2048 lds
    v_mfma_f32_32x32x16_bf16 v[96:111], v[128:131], v[116:119], v[96:111]
    ds_read_b128 v[136:139], v242 offset:28512
    s_add_u32 m0, s33, 3200
    s_nop 0
    buffer_load_dwordx4 v12, s[20:23], s32 offen offset:0 lds
    s_waitcnt lgkmcnt(5)
    v_mfma_f32_32x32x16_bf16 v[16:31], v[140:143], v[132:135], v[16:31]
    ds_read_b128 v[112:115], v9 offset:29568
    s_waitcnt vmcnt(4)
    ds_read_b64_tr_b16 v[120:121], v15 offset:25600
    s_waitcnt lgkmcnt(5)
    v_mfma_f32_32x32x16_bf16 v[32:47], v[144:147], v[132:135], v[32:47]
    ds_read_b64_tr_b16 v[122:123], v15 offset:25984
    ds_read_b64_tr_b16 v[124:125], v15 offset:25632
    s_waitcnt lgkmcnt(5)
    v_mfma_f32_32x32x16_bf16 v[48:63], v[148:151], v[132:135], v[48:63]
    ds_read_b64_tr_b16 v[126:127], v15 offset:26016
    buffer_load_dwordx4 v13, s[20:23], s32 offen offset:1024 lds
    s_waitcnt lgkmcnt(5)
    v_mfma_f32_32x32x16_bf16 v[64:79], v[140:143], v[136:139], v[64:79]
    ds_read_b64_tr_b16 v[128:129], v15 offset:25664
    buffer_load_dwordx4 v14, s[20:23], s32 offen offset:2048 lds
    s_add_u32 s32, s32, 98304
    v_mfma_f32_32x32x16_bf16 v[80:95], v[144:147], v[136:139], v[80:95]
    ds_read_b64_tr_b16 v[130:131], v15 offset:26048
    v_mfma_f32_32x32x16_bf16 v[96:111], v[148:151], v[136:139], v[96:111]
    ds_read_b128 v[116:119], v242 offset:29568
    s_waitcnt lgkmcnt(5)
    v_mfma_f32_32x32x16_bf16 v[16:31], v[120:123], v[112:115], v[16:31]
    ds_read_b128 v[132:135], v9 offset:30624
    ds_read_b64_tr_b16 v[140:141], v15 offset:27136
    s_waitcnt lgkmcnt(5)
    v_mfma_f32_32x32x16_bf16 v[32:47], v[124:127], v[112:115], v[32:47]
    ds_read_b64_tr_b16 v[142:143], v15 offset:27520
    ds_read_b64_tr_b16 v[144:145], v15 offset:27168
    s_waitcnt lgkmcnt(5)
    v_mfma_f32_32x32x16_bf16 v[48:63], v[128:131], v[112:115], v[48:63]
    ds_read_b64_tr_b16 v[146:147], v15 offset:27552
    s_add_u32 m0, s33, 51200
    s_nop 0
    buffer_load_dwordx4 v12, s[16:19], s32 offen offset:0 lds
    s_waitcnt lgkmcnt(5)
    v_mfma_f32_32x32x16_bf16 v[64:79], v[120:123], v[116:119], v[64:79]
    ds_read_b64_tr_b16 v[148:149], v15 offset:27200
    buffer_load_dwordx4 v13, s[16:19], s32 offen offset:1024 lds
    v_mfma_f32_32x32x16_bf16 v[80:95], v[124:127], v[116:119], v[80:95]
    ds_read_b64_tr_b16 v[150:151], v15 offset:27584
    buffer_load_dwordx4 v14, s[16:19], s32 offen offset:2048 lds
    v_mfma_f32_32x32x16_bf16 v[96:111], v[128:131], v[116:119], v[96:111]
    ds_read_b128 v[136:139], v242 offset:30624
    s_add_u32 m0, s33, 54400
    s_nop 0
    buffer_load_dwordx4 v12, s[20:23], s32 offen offset:0 lds
    s_waitcnt lgkmcnt(5)
    v_mfma_f32_32x32x16_bf16 v[16:31], v[140:143], v[132:135], v[16:31]
    ds_read_b128 v[112:115], v9 offset:31680
    s_waitcnt vmcnt(4)
    ds_read_b64_tr_b16 v[120:121], v15 offset:0
    s_waitcnt lgkmcnt(5)
    v_mfma_f32_32x32x16_bf16 v[32:47], v[144:147], v[132:135], v[32:47]
    ds_read_b64_tr_b16 v[122:123], v15 offset:384
    ds_read_b64_tr_b16 v[124:125], v15 offset:32
    s_waitcnt lgkmcnt(5)
    v_mfma_f32_32x32x16_bf16 v[48:63], v[148:151], v[132:135], v[48:63]
    ds_read_b64_tr_b16 v[126:127], v15 offset:416
    buffer_load_dwordx4 v13, s[20:23], s32 offen offset:1024 lds
    s_waitcnt lgkmcnt(5)
    v_mfma_f32_32x32x16_bf16 v[64:79], v[140:143], v[136:139], v[64:79]
    ds_read_b64_tr_b16 v[128:129], v15 offset:64
    buffer_load_dwordx4 v14, s[20:23], s32 offen offset:2048 lds
    s_add_u32 s32, s32, 98304
    v_mfma_f32_32x32x16_bf16 v[80:95], v[144:147], v[136:139], v[80:95]
    ds_read_b64_tr_b16 v[130:131], v15 offset:448
    v_mfma_f32_32x32x16_bf16 v[96:111], v[148:151], v[136:139], v[96:111]
    ds_read_b128 v[116:119], v242 offset:31680
    s_waitcnt lgkmcnt(5)
    v_mfma_f32_32x32x16_bf16 v[16:31], v[120:123], v[112:115], v[16:31]
    ds_read_b128 v[132:135], v9 offset:32736
    ds_read_b64_tr_b16 v[140:141], v15 offset:1536
    s_waitcnt lgkmcnt(5)
    v_mfma_f32_32x32x16_bf16 v[32:47], v[124:127], v[112:115], v[32:47]
    ds_read_b64_tr_b16 v[142:143], v15 offset:1920
    ds_read_b64_tr_b16 v[144:145], v15 offset:1568
    s_waitcnt lgkmcnt(5)
    v_mfma_f32_32x32x16_bf16 v[48:63], v[128:131], v[112:115], v[48:63]
    ds_read_b64_tr_b16 v[146:147], v15 offset:1952
    s_add_u32 m0, s33, 25600
    s_nop 0
    buffer_load_dwordx4 v12, s[16:19], s32 offen offset:0 lds
    s_waitcnt lgkmcnt(5)
    v_mfma_f32_32x32x16_bf16 v[64:79], v[120:123], v[116:119], v[64:79]
    ds_read_b64_tr_b16 v[148:149], v15 offset:1600
    buffer_load_dwordx4 v13, s[16:19], s32 offen offset:1024 lds
    v_mfma_f32_32x32x16_bf16 v[80:95], v[124:127], v[116:119], v[80:95]
    ds_read_b64_tr_b16 v[150:151], v15 offset:1984
    buffer_load_dwordx4 v14, s[16:19], s32 offen offset:2048 lds
    v_mfma_f32_32x32x16_bf16 v[96:111], v[128:131], v[116:119], v[96:111]
    ds_read_b128 v[136:139], v242 offset:32736
    s_add_u32 m0, s33, 28800
    s_nop 0
    buffer_load_dwordx4 v12, s[20:23], s32 offen offset:0 lds
    s_waitcnt lgkmcnt(5)
    v_mfma_f32_32x32x16_bf16 v[16:31], v[140:143], v[132:135], v[16:31]
    ds_read_b128 v[112:115], v9 offset:33792
    s_waitcnt vmcnt(4)
    ds_read_b64_tr_b16 v[120:121], v15 offset:51200
    s_waitcnt lgkmcnt(5)
    v_mfma_f32_32x32x16_bf16 v[32:47], v[144:147], v[132:135], v[32:47]
    ds_read_b64_tr_b16 v[122:123], v15 offset:51584
    ds_read_b64_tr_b16 v[124:125], v15 offset:51232
    s_waitcnt lgkmcnt(5)
    v_mfma_f32_32x32x16_bf16 v[48:63], v[148:151], v[132:135], v[48:63]
    ds_read_b64_tr_b16 v[126:127], v15 offset:51616
    buffer_load_dwordx4 v13, s[20:23], s32 offen offset:1024 lds
    s_waitcnt lgkmcnt(5)
    v_mfma_f32_32x32x16_bf16 v[64:79], v[140:143], v[136:139], v[64:79]
    ds_read_b64_tr_b16 v[128:129], v15 offset:51264
    buffer_load_dwordx4 v14, s[20:23], s32 offen offset:2048 lds
    s_add_u32 s32, s32, 98304
    v_mfma_f32_32x32x16_bf16 v[80:95], v[144:147], v[136:139], v[80:95]
    ds_read_b64_tr_b16 v[130:131], v15 offset:51648
    v_mfma_f32_32x32x16_bf16 v[96:111], v[148:151], v[136:139], v[96:111]
    ds_read_b128 v[116:119], v242 offset:33792
    s_waitcnt lgkmcnt(5)
    v_mfma_f32_32x32x16_bf16 v[16:31], v[120:123], v[112:115], v[16:31]
    ds_read_b128 v[132:135], v9 offset:34848
    ds_read_b64_tr_b16 v[140:141], v15 offset:52736
    s_waitcnt lgkmcnt(5)
    v_mfma_f32_32x32x16_bf16 v[32:47], v[124:127], v[112:115], v[32:47]
    ds_read_b64_tr_b16 v[142:143], v15 offset:53120
    ds_read_b64_tr_b16 v[144:145], v15 offset:52768
    s_waitcnt lgkmcnt(5)
    v_mfma_f32_32x32x16_bf16 v[48:63], v[128:131], v[112:115], v[48:63]
    ds_read_b64_tr_b16 v[146:147], v15 offset:53152
    s_add_u32 m0, s33, 0
    s_nop 0
    buffer_load_dwordx4 v12, s[16:19], s32 offen offset:0 lds
    s_waitcnt lgkmcnt(5)
    v_mfma_f32_32x32x16_bf16 v[64:79], v[120:123], v[116:119], v[64:79]
    ds_read_b64_tr_b16 v[148:149], v15 offset:52800
    buffer_load_dwordx4 v13, s[16:19], s32 offen offset:1024 lds
    v_mfma_f32_32x32x16_bf16 v[80:95], v[124:127], v[116:119], v[80:95]
    ds_read_b64_tr_b16 v[150:151], v15 offset:53184
    buffer_load_dwordx4 v14, s[16:19], s32 offen offset:2048 lds
    v_mfma_f32_32x32x16_bf16 v[96:111], v[128:131], v[116:119], v[96:111]
    ds_read_b128 v[136:139], v242 offset:34848
    s_add_u32 m0, s33, 3200
    s_nop 0
    buffer_load_dwordx4 v12, s[20:23], s32 offen offset:0 lds
    s_waitcnt lgkmcnt(5)
    v_mfma_f32_32x32x16_bf16 v[16:31], v[140:143], v[132:135], v[16:31]
    ds_read_b128 v[112:115], v9 offset:35904
    s_waitcnt vmcnt(4)
    ds_read_b64_tr_b16 v[120:121], v15 offset:25600
    s_waitcnt lgkmcnt(5)
    v_mfma_f32_32x32x16_bf16 v[32:47], v[144:147], v[132:135], v[32:47]
    ds_read_b64_tr_b16 v[122:123], v15 offset:25984
    ds_read_b64_tr_b16 v[124:125], v15 offset:25632
    s_waitcnt lgkmcnt(5)
    v_mfma_f32_32x32x16_bf16 v[48:63], v[148:151], v[132:135], v[48:63]
    ds_read_b64_tr_b16 v[126:127], v15 offset:26016
    buffer_load_dwordx4 v13, s[20:23], s32 offen offset:1024 lds
    s_waitcnt lgkmcnt(5)
    v_mfma_f32_32x32x16_bf16 v[64:79], v[140:143], v[136:139], v[64:79]
    ds_read_b64_tr_b16 v[128:129], v15 offset:25664
    buffer_load_dwordx4 v14, s[20:23], s32 offen offset:2048 lds
    s_add_u32 s32, s32, 98304
    v_mfma_f32_32x32x16_bf16 v[80:95], v[144:147], v[136:139], v[80:95]
    ds_read_b64_tr_b16 v[130:131], v15 offset:26048
    v_mfma_f32_32x32x16_bf16 v[96:111], v[148:151], v[136:139], v[96:111]
    ds_read_b128 v[116:119], v242 offset:35904
    s_waitcnt lgkmcnt(5)
    v_mfma_f32_32x32x16_bf16 v[16:31], v[120:123], v[112:115], v[16:31]
    ds_read_b128 v[132:135], v9 offset:36960
    ds_read_b64_tr_b16 v[140:141], v15 offset:27136
    s_waitcnt lgkmcnt(5)
    v_mfma_f32_32x32x16_bf16 v[32:47], v[124:127], v[112:115], v[32:47]
    ds_read_b64_tr_b16 v[142:143], v15 offset:27520
    ds_read_b64_tr_b16 v[144:145], v15 offset:27168
    s_waitcnt lgkmcnt(5)
    v_mfma_f32_32x32x16_bf16 v[48:63], v[128:131], v[112:115], v[48:63]
    ds_read_b64_tr_b16 v[146:147], v15 offset:27552
    s_add_u32 m0, s33, 51200
    s_nop 0
    buffer_load_dwordx4 v12, s[16:19], s32 offen offset:0 lds
    s_waitcnt lgkmcnt(5)
    v_mfma_f32_32x32x16_bf16 v[64:79], v[120:123], v[116:119], v[64:79]
    ds_read_b64_tr_b16 v[148:149], v15 offset:27200
    buffer_load_dwordx4 v13, s[16:19], s32 offen offset:1024 lds
    v_mfma_f32_32x32x16_bf16 v[80:95], v[124:127], v[116:119], v[80:95]
    ds_read_b64_tr_b16 v[150:151], v15 offset:27584
    buffer_load_dwordx4 v14, s[16:19], s32 offen offset:2048 lds
    v_mfma_f32_32x32x16_bf16 v[96:111], v[128:131], v[116:119], v[96:111]
    ds_read_b128 v[136:139], v242 offset:36960
    s_add_u32 m0, s33, 54400
    s_nop 0
    buffer_load_dwordx4 v12, s[20:23], s32 offen offset:0 lds
    s_waitcnt lgkmcnt(5)
    v_mfma_f32_32x32x16_bf16 v[16:31], v[140:143], v[132:135], v[16:31]
    ds_read_b128 v[112:115], v9 offset:38016
    s_waitcnt vmcnt(4)
    ds_read_b64_tr_b16 v[120:121], v15 offset:0
    s_waitcnt lgkmcnt(5)
    v_mfma_f32_32x32x16_bf16 v[32:47], v[144:147], v[132:135], v[32:47]
    ds_read_b64_tr_b16 v[122:123], v15 offset:384
    ds_read_b64_tr_b16 v[124:125], v15 offset:32
    s_waitcnt lgkmcnt(5)
    v_mfma_f32_32x32x16_bf16 v[48:63], v[148:151], v[132:135], v[48:63]
    ds_read_b64_tr_b16 v[126:127], v15 offset:416
    buffer_load_dwordx4 v13, s[20:23], s32 offen offset:1024 lds
    s_waitcnt lgkmcnt(5)
    v_mfma_f32_32x32x16_bf16 v[64:79], v[140:143], v[136:139], v[64:79]
    ds_read_b64_tr_b16 v[128:129], v15 offset:64
    buffer_load_dwordx4 v14, s[20:23], s32 offen offset:2048 lds
    s_add_u32 s32, s32, 98304
    v_mfma_f32_32x32x16_bf16 v[80:95], v[144:147], v[136:139], v[80:95]
    ds_read_b64_tr_b16 v[130:131], v15 offset:448
    v_mfma_f32_32x32x16_bf16 v[96:111], v[148:151], v[136:139], v[96:111]
    ds_read_b128 v[116:119], v242 offset:38016
    s_waitcnt lgkmcnt(5)
    v_mfma_f32_32x32x16_bf16 v[16:31], v[120:123], v[112:115], v[16:31]
    ds_read_b128 v[132:135], v9 offset:39072
    ds_read_b64_tr_b16 v[140:141], v15 offset:1536
    s_waitcnt lgkmcnt(5)
    v_mfma_f32_32x32x16_bf16 v[32:47], v[124:127], v[112:115], v[32:47]
    ds_read_b64_tr_b16 v[142:143], v15 offset:1920
    ds_read_b64_tr_b16 v[144:145], v15 offset:1568
    s_waitcnt lgkmcnt(5)
    v_mfma_f32_32x32x16_bf16 v[48:63], v[128:131], v[112:115], v[48:63]
    ds_read_b64_tr_b16 v[146:147], v15 offset:1952
    s_add_u32 m0, s29, 25600
    s_nop 0
    buffer_load_dwordx4 v232, s[92:95], s39 offen offset:0 lds
    s_waitcnt lgkmcnt(5)
    v_mfma_f32_32x32x16_bf16 v[64:79], v[120:123], v[116:119], v[64:79]
    ds_read_b64_tr_b16 v[148:149], v15 offset:1600
    buffer_load_dwordx4 v233, s[92:95], s39 offen offset:1024 lds
    v_mfma_f32_32x32x16_bf16 v[80:95], v[124:127], v[116:119], v[80:95]
    ds_read_b64_tr_b16 v[150:151], v15 offset:1984
    buffer_load_dwordx4 v234, s[92:95], s39 offen offset:2048 lds
    v_mfma_f32_32x32x16_bf16 v[96:111], v[128:131], v[116:119], v[96:111]
    ds_read_b128 v[136:139], v242 offset:39072
    buffer_load_dwordx4 v235, s[92:95], s39 offen offset:3072 lds
    s_waitcnt lgkmcnt(5)
    v_mfma_f32_32x32x16_bf16 v[16:31], v[140:143], v[132:135], v[16:31]
    ds_read_b128 v[112:115], v9 offset:40128
    s_waitcnt vmcnt(4)
    ds_read_b64_tr_b16 v[120:121], v15 offset:51200
    s_waitcnt lgkmcnt(5)
    v_mfma_f32_32x32x16_bf16 v[32:47], v[144:147], v[132:135], v[32:47]
    ds_read_b64_tr_b16 v[122:123], v15 offset:51584
    ds_read_b64_tr_b16 v[124:125], v15 offset:51232
    s_waitcnt lgkmcnt(5)
    v_mfma_f32_32x32x16_bf16 v[48:63], v[148:151], v[132:135], v[48:63]
    ds_read_b64_tr_b16 v[126:127], v15 offset:51616
    s_add_u32 m0, s29, 29696
    s_nop 0
    buffer_load_dwordx4 v236, s[92:95], s39 offen lds
    s_add_u32 s39, s39, 20480
    s_waitcnt lgkmcnt(5)
    v_mfma_f32_32x32x16_bf16 v[64:79], v[140:143], v[136:139], v[64:79]
    ds_read_b64_tr_b16 v[128:129], v15 offset:51264
    ds_read_b32 v8, v11
    s_waitcnt lgkmcnt(0)
    v_cmp_gt_u32 vcc, 12, v8
    s_cmp_eq_u64 vcc, 0
    s_cbranch_scc0 L_psl_20
L_pok_18:
    v_mfma_f32_32x32x16_bf16 v[80:95], v[144:147], v[136:139], v[80:95]
    ds_read_b64_tr_b16 v[130:131], v15 offset:51648
    v_mfma_f32_32x32x16_bf16 v[96:111], v[148:151], v[136:139], v[96:111]
    ds_read_b128 v[116:119], v242 offset:40128
    v_mfma_f32_32x32x16_bf16 v[16:31], v[120:123], v[112:115], v[16:31]
    ds_read_b128 v[132:135], v9 offset:41184
    ds_read_b64_tr_b16 v[140:141], v15 offset:52736
    v_mfma_f32_32x32x16_bf16 v[32:47], v[124:127], v[112:115], v[32:47]
    ds_read_b64_tr_b16 v[142:143], v15 offset:53120
    ds_read_b64_tr_b16 v[144:145], v15 offset:52768
    s_waitcnt lgkmcnt(5)
    v_mfma_f32_32x32x16_bf16 v[48:63], v[128:131], v[112:115], v[48:63]
    ds_read_b64_tr_b16 v[146:147], v15 offset:53152
    s_add_u32 m0, s29, 0
    s_nop 0
    buffer_load_dwordx4 v232, s[92:95], s39 offen offset:0 lds
    s_waitcnt lgkmcnt(5)
    v_mfma_f32_32x32x16_bf16 v[64:79], v[120:123], v[116:119], v[64:79]
    ds_read_b64_tr_b16 v[148:149], v15 offset:52800
    buffer_load_dwordx4 v233, s[92:95], s39 offen offset:1024 lds
    v_mfma_f32_32x32x16_bf16 v[80:95], v[124:127], v[116:119], v[80:95]
    ds_read_b64_tr_b16 v[150:151], v15 offset:53184
    buffer_load_dwordx4 v234, s[92:95], s39 offen offset:2048 lds
    v_mfma_f32_32x32x16_bf16 v[96:111], v[128:131], v[116:119], v[96:111]
    ds_read_b128 v[136:139], v242 offset:41184
    buffer_load_dwordx4 v235, s[92:95], s39 offen offset:3072 lds
    s_waitcnt lgkmcnt(5)
    v_mfma_f32_32x32x16_bf16 v[16:31], v[140:143], v[132:135], v[16:31]
    s_waitcnt lgkmcnt(3)
    v_mfma_f32_32x32x16_bf16 v[32:47], v[144:147], v[132:135], v[32:47]
    s_waitcnt lgkmcnt(1)
    v_mfma_f32_32x32x16_bf16 v[48:63], v[148:151], v[132:135], v[48:63]
    s_add_u32 m0, s29, 4096
    s_nop 0
    buffer_load_dwordx4 v236, s[92:95], s39 offen lds
    s_add_u32 s39, s39, 20480
    s_waitcnt lgkmcnt(0)
    v_mfma_f32_32x32x16_bf16 v[64:79], v[140:143], v[136:139], v[64:79]
    v_mfma_f32_32x32x16_bf16 v[80:95], v[144:147], v[136:139], v[80:95]
    v_mfma_f32_32x32x16_bf16 v[96:111], v[148:151], v[136:139], v[96:111]
    s_add_u32 m0, s29, 51200
    s_nop 0
    buffer_load_dwordx4 v232, s[92:95], s39 offen offset:0 lds
    buffer_load_dwordx4 v233, s[92:95], s39 offen offset:1024 lds
    buffer_load_dwordx4 v234, s[92:95], s39 offen offset:2048 lds
    buffer_load_dwordx4 v235, s[92:95], s39 offen offset:3072 lds
    s_add_u32 m0, s29, 55296
    s_nop 0
    buffer_load_dwordx4 v236, s[92:95], s39 offen lds
    s_add_u32 s39, s39, 204800
    s_sub_u32 s60, s39, 1966080
    s_cmp_ge_u32 s39, 1966080
    s_cselect_b32 s39, s60, s39
    s_mov_b64 exec, 1
    v_mov_b32 v8, 5
    ds_write_b32 v7, v8
    s_mov_b64 exec, -1
    s_cmp_ge_u32 s5, 4
    s_cselect_b64 vcc, -1, 0
    s_setprio 3
    v_pk_mul_f32 v[16:17], v[16:17], v[24:25]
    v_pk_mul_f32 v[18:19], v[18:19], v[26:27]
    v_pk_mul_f32 v[20:21], v[20:21], v[28:29]
    v_pk_mul_f32 v[22:23], v[22:23], v[30:31]
    v_cvt_pk_bf16_f32 v24, v16, v17
    v_cvt_pk_bf16_f32 v25, v18, v19
    v_cvt_pk_bf16_f32 v26, v20, v21
    v_cvt_pk_bf16_f32 v27, v22, v23
    buffer_store_dwordx4 v[24:27], v2, s[24:27], s36 offen offset:0 sc1
    v_pk_mul_f32 v[32:33], v[32:33], v[40:41]
    v_pk_mul_f32 v[34:35], v[34:35], v[42:43]
    v_pk_mul_f32 v[36:37], v[36:37], v[44:45]
    v_pk_mul_f32 v[38:39], v[38:39], v[46:47]
    v_cvt_pk_bf16_f32 v40, v32, v33
    v_cvt_pk_bf16_f32 v41, v34, v35
    v_cvt_pk_bf16_f32 v42, v36, v37
    v_cvt_pk_bf16_f32 v43, v38, v39
    buffer_store_dwordx4 v[40:43], v2, s[24:27], s36 offen offset:1024 sc1
    v_pk_mul_f32 v[48:49], v[48:49], v[56:57]
    v_pk_mul_f32 v[50:51], v[50:51], v[58:59]
    v_pk_mul_f32 v[52:53], v[52:53], v[60:61]
    v_pk_mul_f32 v[54:55], v[54:55], v[62:63]
    v_cvt_pk_bf16_f32 v56, v48, v49
    v_cvt_pk_bf16_f32 v57, v50, v51
    v_cvt_pk_bf16_f32 v58, v52, v53
    v_cvt_pk_bf16_f32 v59, v54, v55
    buffer_store_dwordx4 v[56:59], v2, s[24:27], s36 offen offset:2048 sc1
    v_pk_mul_f32 v[64:65], v[64:65], v[72:73]
    v_pk_mul_f32 v[66:67], v[66:67], v[74:75]
    v_pk_mul_f32 v[68:69], v[68:69], v[76:77]
    v_pk_mul_f32 v[70:71], v[70:71], v[78:79]
    v_cvt_pk_bf16_f32 v72, v64, v65
    v_cvt_pk_bf16_f32 v73, v66, v67
    v_cvt_pk_bf16_f32 v74, v68, v69
    v_cvt_pk_bf16_f32 v75, v70, v71
    buffer_store_dwordx4 v[72:75], v2, s[24:27], s37 offen offset:0 sc1
    v_pk_mul_f32 v[80:81], v[80:81], v[88:89]
    v_pk_mul_f32 v[82:83], v[82:83], v[90:91]
    v_pk_mul_f32 v[84:85], v[84:85], v[92:93]
    v_pk_mul_f32 v[86:87], v[86:87], v[94:95]
    v_cvt_pk_bf16_f32 v88, v80, v81
    v_cvt_pk_bf16_f32 v89, v82, v83
    v_cvt_pk_bf16_f32 v90, v84, v85
    v_cvt_pk_bf16_f32 v91, v86, v87
    buffer_store_dwordx4 v[88:91], v2, s[24:27], s37 offen offset:1024 sc1
    v_pk_mul_f32 v[96:97], v[96:97], v[104:105]
    v_pk_mul_f32 v[98:99], v[98:99], v[106:107]
    v_pk_mul_f32 v[100:101], v[100:101], v[108:109]
    v_pk_mul_f32 v[102:103], v[102:103], v[110:111]
    v_cvt_pk_bf16_f32 v104, v96, v97
    v_cvt_pk_bf16_f32 v105, v98, v99
    v_cvt_pk_bf16_f32 v106, v100, v101
    v_cvt_pk_bf16_f32 v107, v102, v103
    buffer_store_dwordx4 v[104:107], v2, s[24:27], s37 offen offset:2048 sc1
    v_cndmask_b32 v136, v24, v72, vcc
    v_cndmask_b32 v137, v25, v73, vcc
    v_cndmask_b32 v138, v26, v74, vcc
    v_cndmask_b32 v139, v27, v75, vcc
    v_cndmask_b32 v140, v40, v88, vcc
    v_cndmask_b32 v141, v41, v89, vcc
    v_cndmask_b32 v142, v42, v90, vcc
    v_cndmask_b32 v143, v43, v91, vcc
    v_cndmask_b32 v144, v56, v104, vcc
    v_cndmask_b32 v145, v57, v105, vcc
    v_cndmask_b32 v146, v58, v106, vcc
    v_cndmask_b32 v147, v59, v107, vcc
    v_mov_b32 v4, s62
    s_lshl_b32 s36, s4, 1
    s_lshr_b32 s37, s5, 2
    s_add_u32 s36, s36, s37
    s_mul_i32 s43, s36, 40960
    s_add_u32 s43, s43, s38
    s_mul_i32 s37, s3, 80
    s_add_u32 s43, s43, s37
    s_mul_i32 s37, s36, 98304
    s_mul_i32 s36, s36, 40960
    s_mul_i32 s61, s3, 10240
    s_add_u32 s36, s36, s61
    s_add_u32 s7, s7, 12288
    s_sub_u32 s61, s7, 98304
    s_cmp_ge_u32 s7, 98304
    s_cselect_b32 s7, s61, s7
    s_add_u32 s64, s7, s37
    s_add_u32 s7, s7, 12288
    s_sub_u32 s61, s7, 98304
    s_cmp_ge_u32 s7, 98304
    s_cselect_b32 s7, s61, s7
    s_add_u32 s65, s7, s37
    s_add_u32 s7, s7, 12288
    s_sub_u32 s61, s7, 98304
    s_cmp_ge_u32 s7, 98304
    s_cselect_b32 s7, s61, s7
    s_add_u32 s66, s7, s37
    s_add_u32 s7, s7, 12288
    s_sub_u32 s61, s7, 98304
    s_cmp_ge_u32 s7, 98304
    s_cselect_b32 s7, s61, s7
    s_add_u32 s67, s7, s37
    s_add_u32 s7, s7, 12288
    s_sub_u32 s61, s7, 98304
    s_cmp_ge_u32 s7, 98304
    s_cselect_b32 s7, s61, s7
    s_add_u32 s68, s7, s37
    s_add_u32 s7, s7, 12288
    s_sub_u32 s61, s7, 98304
    s_cmp_ge_u32 s7, 98304
    s_cselect_b32 s7, s61, s7
    s_add_u32 s69, s7, s37
    s_add_u32 s7, s7, 12288
    s_sub_u32 s61, s7, 98304
    s_cmp_ge_u32 s7, 98304
    s_cselect_b32 s7, s61, s7
    s_add_u32 s70, s7, s37
    s_setprio 0
    s_waitcnt vmcnt(16)
    ds_read_b64_tr_b16 v[96:97], v252 offset:25600
    ds_read_b64_tr_b16 v[98:99], v252 offset:26880
    ds_read_b64_tr_b16 v[100:101], v252 offset:25608
    ds_read_b64_tr_b16 v[102:103], v252 offset:26888
    ds_read_b64_tr_b16 v[104:105], v252 offset:25616
    ds_read_b64_tr_b16 v[106:107], v252 offset:26896
    ds_read_b64_tr_b16 v[108:109], v252 offset:25624
    ds_read_b64_tr_b16 v[110:111], v252 offset:26904
    ds_read_b64_tr_b16 v[112:113], v252 offset:25632
    ds_read_b64_tr_b16 v[114:115], v252 offset:26912
    s_setprio 0
    s_waitcnt lgkmcnt(8)
    v_mfma_f32_32x32x16_bf16 v[16:31], v[96:99], v[136:139], 0
    s_waitcnt vmcnt(11)
    ds_read_b64_tr_b16 v[116:117], v252 offset:0
    ds_read_b64_tr_b16 v[118:119], v252 offset:1280
    ds_read_b64_tr_b16 v[120:121], v252 offset:8
    buffer_load_dwordx4 v[242:245], v254, s[8:11], s43 offen
    s_waitcnt lgkmcnt(9)
    v_mfma_f32_32x32x16_bf16 v[32:47], v[100:103], v[136:139], 0
    ds_read_b64_tr_b16 v[122:123], v252 offset:1288
    ds_read_b64_tr_b16 v[124:125], v252 offset:16
    ds_read_b64_tr_b16 v[126:127], v252 offset:1296
    s_waitcnt lgkmcnt(6)
    s_add_u32 m0, s29, 25600
    s_nop 0
    buffer_load_dwordx4 v232, s[92:95], s39 offen offset:0 lds
    buffer_load_dwordx4 v[246:249], v254, s[8:11], s43 offen offset:16
    v_mfma_f32_32x32x16_bf16 v[48:63], v[104:107], v[136:139], 0
    ds_read_b64_tr_b16 v[128:129], v252 offset:24
    ds_read_b64_tr_b16 v[130:131], v252 offset:1304
    buffer_load_dwordx4 v233, s[92:95], s39 offen offset:1024 lds
    buffer_load_dwordx2 v[250:251], v254, s[8:11], s43 offen offset:32
    v_mfma_f32_32x32x16_bf16 v[64:79], v[108:111], v[136:139], 0
    ds_read_b64_tr_b16 v[132:133], v252 offset:32
    ds_read_b64_tr_b16 v[134:135], v252 offset:1312
    buffer_load_dwordx4 v234, s[92:95], s39 offen offset:2048 lds
    buffer_load_dwordx4 v235, s[92:95], s39 offen offset:3072 lds
    v_mfma_f32_32x32x16_bf16 v[80:95], v[112:115], v[136:139], 0
    s_add_u32 m0, s29, 29696
    s_nop 0
    buffer_load_dwordx4 v236, s[92:95], s39 offen lds
    s_add_u32 s39, s39, 20480
    s_waitcnt vmcnt(8)
    s_mov_b64 exec, 1
    buffer_store_dword v4, v5, s[56:59], s42 offen sc1
    s_mov_b64 exec, -1
    s_waitcnt lgkmcnt(8)
    v_mfma_f32_32x32x16_bf16 v[16:31], v[116:119], v[140:143], v[16:31]
    ds_read_b64_tr_b16 v[96:97], v252 offset:51200
    ds_read_b64_tr_b16 v[98:99], v252 offset:52480
    ds_read_b64_tr_b16 v[100:101], v252 offset:51208
    s_waitcnt lgkmcnt(9)
    v_mfma_f32_32x32x16_bf16 v[32:47], v[120:123], v[140:143], v[32:47]
    ds_read_b64_tr_b16 v[102:103], v252 offset:52488
    ds_read_b64_tr_b16 v[104:105], v252 offset:51216
    ds_read_b64_tr_b16 v[106:107], v252 offset:52496
    s_waitcnt lgkmcnt(6)
    s_add_u32 m0, s29, 0
    s_nop 0
    buffer_load_dwordx4 v232, s[92:95], s39 offen offset:0 lds
    v_mfma_f32_32x32x16_bf16 v[48:63], v[124:127], v[140:143], v[48:63]
    ds_read_b64_tr_b16 v[108:109], v252 offset:51224
    ds_read_b64_tr_b16 v[110:111], v252 offset:52504
    buffer_load_dwordx4 v233, s[92:95], s39 offen offset:1024 lds
    v_mfma_f32_32x32x16_bf16 v[64:79], v[128:131], v[140:143], v[64:79]
    ds_read_b64_tr_b16 v[112:113], v252 offset:51232
    ds_read_b64_tr_b16 v[114:115], v252 offset:52512
    buffer_load_dwordx4 v234, s[92:95], s39 offen offset:2048 lds
    buffer_load_dwordx4 v235, s[92:95], s39 offen offset:3072 lds
    v_mfma_f32_32x32x16_bf16 v[80:95], v[132:135], v[140:143], v[80:95]
    s_add_u32 m0, s29, 4096
    s_nop 0
    buffer_load_dwordx4 v236, s[92:95], s39 offen lds
    s_add_u32 s39, s39, 20480
    s_waitcnt lgkmcnt(8)
    v_mfma_f32_32x32x16_bf16 v[16:31], v[96:99], v[144:147], v[16:31]
    s_waitcnt vmcnt(6)
    ds_read_b64_tr_b16 v[116:117], v252 offset:25600
    ds_read_b64_tr_b16 v[118:119], v252 offset:26880
    ds_read_b64_tr_b16 v[120:121], v252 offset:25608
    s_waitcnt lgkmcnt(9)
    v_mfma_f32_32x32x16_bf16 v[32:47], v[100:103], v[144:147], v[32:47]
    ds_read_b64_tr_b16 v[122:123], v252 offset:26888
    ds_read_b64_tr_b16 v[124:125], v252 offset:25616
    ds_read_b64_tr_b16 v[126:127], v252 offset:26896
    s_waitcnt lgkmcnt(6)
    buffer_load_dword v152, v253, s[56:59], s30 offen sc1
    v_mfma_f32_32x32x16_bf16 v[48:63], v[104:107], v[144:147], v[48:63]
    ds_read_b64_tr_b16 v[128:129], v252 offset:25624
    ds_read_b64_tr_b16 v[130:131], v252 offset:26904
    s_add_u32 m0, s29, 51200
    s_nop 0
    buffer_load_dwordx4 v232, s[92:95], s39 offen offset:0 lds
    v_mfma_f32_32x32x16_bf16 v[64:79], v[108:111], v[144:147], v[64:79]
    ds_read_b64_tr_b16 v[132:133], v252 offset:25632
    ds_read_b64_tr_b16 v[134:135], v252 offset:26912
    buffer_load_dwordx4 v233, s[92:95], s39 offen offset:1024 lds
    buffer_load_dwordx4 v234, s[92:95], s39 offen offset:2048 lds
    v_mfma_f32_32x32x16_bf16 v[80:95], v[112:115], v[144:147], v[80:95]
    buffer_load_dwordx4 v235, s[92:95], s39 offen offset:3072 lds
    s_add_u32 m0, s29, 55296
    s_nop 0
    buffer_load_dwordx4 v236, s[92:95], s39 offen lds
    s_add_u32 s39, s39, 204800
    s_sub_u32 s60, s39, 1966080
    s_cmp_ge_u32 s39, 1966080
    s_cselect_b32 s39, s60, s39
    s_waitcnt vmcnt(5)
    v_cmp_ne_u32 vcc, s62, v152
    s_cmp_eq_u64 vcc, 0
    s_cbranch_scc1 L_g_hok
    s_mov_b32 s63, 16384
L_glp_22:
    buffer_load_dword v8, v253, s[56:59], s30 offen offset:0 sc1
    s_waitcnt vmcnt(0)
    v_xor_b32 v8, s62, v8
    v_cmp_ne_u32 vcc, 0, v8
    s_cmp_eq_u64 vcc, 0
    s_cbranch_scc1 L_gok_21
    s_sleep 3
    s_sub_u32 s63, s63, 1
    s_cbranch_scc0 L_glp_22
L_gok_21:
L_g_hok:
    buffer_load_dwordx4 v[148:151], v2, s[24:27], s64 offen offset:0 sc1
    buffer_load_dwordx4 v[152:155], v2, s[24:27], s64 offen offset:1024 sc1
    buffer_load_dwordx4 v[156:159], v2, s[24:27], s64 offen offset:2048 sc1
    buffer_load_dwordx4 v[160:163], v2, s[24:27], s65 offen offset:0 sc1
    buffer_load_dwordx4 v[164:167], v2, s[24:27], s65 offen offset:1024 sc1
    buffer_load_dwordx4 v[168:171], v2, s[24:27], s65 offen offset:2048 sc1
    s_waitcnt vmcnt(5) lgkmcnt(8)
    v_mfma_f32_32x32x16_bf16 v[16:31], v[116:119], v[148:151], v[16:31]
    ds_read_b64_tr_b16 v[96:97], v252 offset:0
    ds_read_b64_tr_b16 v[98:99], v252 offset:1280
    ds_read_b64_tr_b16 v[100:101], v252 offset:8
    buffer_load_dwordx4 v[172:175], v2, s[24:27], s66 offen offset:0 sc1
    s_waitcnt lgkmcnt(9)
    v_mfma_f32_32x32x16_bf16 v[32:47], v[120:123], v[148:151], v[32:47]
    ds_read_b64_tr_b16 v[102:103], v252 offset:1288
    ds_read_b64_tr_b16 v[104:105], v252 offset:16
    ds_read_b64_tr_b16 v[106:107], v252 offset:1296
    s_waitcnt lgkmcnt(6)
    s_add_u32 m0, s29, 25600
    s_nop 0
    buffer_load_dwordx4 v232, s[92:95], s39 offen offset:0 lds
    buffer_load_dwordx4 v[176:179], v2, s[24:27], s66 offen offset:1024 sc1
    v_mfma_f32_32x32x16_bf16 v[48:63], v[124:127], v[148:151], v[48:63]
    ds_read_b64_tr_b16 v[108:109], v252 offset:24
    ds_read_b64_tr_b16 v[110:111], v252 offset:1304
    buffer_load_dwordx4 v233, s[92:95], s39 offen offset:1024 lds
    buffer_load_dwordx4 v[180:183], v2, s[24:27], s66 offen offset:2048 sc1
    v_mfma_f32_32x32x16_bf16 v[64:79], v[128:131], v[148:151], v[64:79]
    ds_read_b64_tr_b16 v[112:113], v252 offset:32
    ds_read_b64_tr_b16 v[114:115], v252 offset:1312
    buffer_load_dwordx4 v234, s[92:95], s39 offen offset:2048 lds
    buffer_load_dwordx4 v235, s[92:95], s39 offen offset:3072 lds
    buffer_load_dwordx4 v[184:187], v2, s[24:27], s67 offen offset:0 sc1
    v_mfma_f32_32x32x16_bf16 v[80:95], v[132:135], v[148:151], v[80:95]
    s_add_u32 m0, s29, 29696
    s_nop 0
    buffer_load_dwordx4 v236, s[92:95], s39 offen lds
    s_add_u32 s39, s39, 20480
    buffer_load_dwordx4 v[188:191], v2, s[24:27], s67 offen offset:1024 sc1
    s_waitcnt vmcnt(14) lgkmcnt(8)
    v_mfma_f32_32x32x16_bf16 v[16:31], v[96:99], v[152:155], v[16:31]
    ds_read_b64_tr_b16 v[116:117], v252 offset:51200
    ds_read_b64_tr_b16 v[118:119], v252 offset:52480
    ds_read_b64_tr_b16 v[120:121], v252 offset:51208
    buffer_load_dwordx4 v[192:195], v2, s[24:27], s67 offen offset:2048 sc1
    s_waitcnt lgkmcnt(9)
    v_mfma_f32_32x32x16_bf16 v[32:47], v[100:103], v[152:155], v[32:47]
    ds_read_b64_tr_b16 v[122:123], v252 offset:52488
    ds_read_b64_tr_b16 v[124:125], v252 offset:51216
    ds_read_b64_tr_b16 v[126:127], v252 offset:52496
    s_waitcnt lgkmcnt(6)
    s_add_u32 m0, s29, 0
    s_nop 0
    buffer_load_dwordx4 v232, s[92:95], s39 offen offset:0 lds
    buffer_load_dwordx4 v[196:199], v2, s[24:27], s68 offen offset:0 sc1
    v_mfma_f32_32x32x16_bf16 v[48:63], v[104:107], v[152:155], v[48:63]
    ds_read_b64_tr_b16 v[128:129], v252 offset:51224
    ds_read_b64_tr_b16 v[130:131], v252 offset:52504
    buffer_load_dwordx4 v233, s[92:95], s39 offen offset:1024 lds
    buffer_load_dwordx4 v[200:203], v2, s[24:27], s68 offen offset:1024 sc1
    v_mfma_f32_32x32x16_bf16 v[64:79], v[108:111], v[152:155], v[64:79]
    ds_read_b64_tr_b16 v[132:133], v252 offset:51232
    ds_read_b64_tr_b16 v[134:135], v252 offset:52512
    buffer_load_dwordx4 v234, s[92:95], s39 offen offset:2048 lds
    buffer_load_dwordx4 v235, s[92:95], s39 offen offset:3072 lds
    buffer_load_dwordx4 v[204:207], v2, s[24:27], s68 offen offset:2048 sc1
    v_mfma_f32_32x32x16_bf16 v[80:95], v[112:115], v[152:155], v[80:95]
    s_add_u32 m0, s29, 4096
    s_nop 0
    buffer_load_dwordx4 v236, s[92:95], s39 offen lds
    s_add_u32 s39, s39, 20480
    buffer_load_dwordx4 v[208:211], v2, s[24:27], s69 offen offset:0 sc1
    s_waitcnt vmcnt(23) lgkmcnt(8)
    v_mfma_f32_32x32x16_bf16 v[16:31], v[116:119], v[156:159], v[16:31]
    s_waitcnt vmcnt(11)
    ds_read_b64_tr_b16 v[96:97], v252 offset:25600
    ds_read_b64_tr_b16 v[98:99], v252 offset:26880
    ds_read_b64_tr_b16 v[100:101], v252 offset:25608
    buffer_load_dwordx4 v[212:215], v2, s[24:27], s69 offen offset:1024 sc1
    s_waitcnt lgkmcnt(9)
    v_mfma_f32_32x32x16_bf16 v[32:47], v[120:123], v[156:159], v[32:47]
    ds_read_b64_tr_b16 v[102:103], v252 offset:26888
    ds_read_b64_tr_b16 v[104:105], v252 offset:25616
    ds_read_b64_tr_b16 v[106:107], v252 offset:26896
    s_waitcnt lgkmcnt(6)
    s_add_u32 m0, s29, 51200
    s_nop 0
    buffer_load_dwordx4 v232, s[92:95], s39 offen offset:0 lds
    buffer_load_dwordx4 v[216:219], v2, s[24:27], s69 offen offset:2048 sc1
    v_mfma_f32_32x32x16_bf16 v[48:63], v[124:127], v[156:159], v[48:63]
    ds_read_b64_tr_b16 v[108:109], v252 offset:25624
    ds_read_b64_tr_b16 v[110:111], v252 offset:26904
    buffer_load_dwordx4 v233, s[92:95], s39 offen offset:1024 lds
    buffer_load_dwordx4 v[220:223], v2, s[24:27], s70 offen offset:0 sc1
    v_mfma_f32_32x32x16_bf16 v[64:79], v[128:131], v[156:159], v[64:79]
    ds_read_b64_tr_b16 v[112:113], v252 offset:25632
    ds_read_b64_tr_b16 v[114:115], v252 offset:26912
    buffer_load_dwordx4 v234, s[92:95], s39 offen offset:2048 lds
    buffer_load_dwordx4 v235, s[92:95], s39 offen offset:3072 lds
    buffer_load_dwordx4 v[224:227], v2, s[24:27], s70 offen offset:1024 sc1
    v_mfma_f32_32x32x16_bf16 v[80:95], v[132:135], v[156:159], v[80:95]
    s_add_u32 m0, s29, 55296
    s_nop 0
    buffer_load_dwordx4 v236, s[92:95], s39 offen lds
    s_add_u32 s39, s39, 204800
    s_sub_u32 s60, s39, 1966080
    s_cmp_ge_u32 s39, 1966080
    s_cselect_b32 s39, s60, s39
    buffer_load_dwordx4 v[228:231], v2, s[24:27], s70 offen offset:2048 sc1
    s_waitcnt lgkmcnt(8)
    v_mfma_f32_32x32x16_bf16 v[16:31], v[96:99], v[160:163], v[16:31]
    s_waitcnt vmcnt(11)
    ds_read_b64_tr_b16 v[116:117], v252 offset:0
    ds_read_b64_tr_b16 v[118:119], v252 offset:1280
    ds_read_b64_tr_b16 v[120:121], v252 offset:8
    s_waitcnt lgkmcnt(9)
    v_mfma_f32_32x32x16_bf16 v[32:47], v[100:103], v[160:163], v[32:47]
    ds_read_b64_tr_b16 v[122:123], v252 offset:1288
    ds_read_b64_tr_b16 v[124:125], v252 offset:16
    ds_read_b64_tr_b16 v[126:127], v252 offset:1296
    s_waitcnt lgkmcnt(6)
    s_add_u32 m0, s29, 25600
    s_nop 0
    buffer_load_dwordx4 v232, s[92:95], s39 offen offset:0 lds
    v_mfma_f32_32x32x16_bf16 v[48:63], v[104:107], v[160:163], v[48:63]
    ds_read_b64_tr_b16 v[128:129], v252 offset:24
    ds_read_b64_tr_b16 v[130:131], v252 offset:1304
    buffer_load_dwordx4 v233, s[92:95], s39 offen offset:1024 lds
    v_mfma_f32_32x32x16_bf16 v[64:79], v[108:111], v[160:163], v[64:79]
    ds_read_b64_tr_b16 v[132:133], v252 offset:32
    ds_read_b64_tr_b16 v[134:135], v252 offset:1312
    buffer_load_dwordx4 v234, s[92:95], s39 offen offset:2048 lds
    buffer_load_dwordx4 v235, s[92:95], s39 offen offset:3072 lds
    v_mfma_f32_32x32x16_bf16 v[80:95], v[112:115], v[160:163], v[80:95]
    s_add_u32 m0, s29, 29696
    s_nop 0
    buffer_load_dwordx4 v236, s[92:95], s39 offen lds
    s_add_u32 s39, s39, 20480
    s_waitcnt lgkmcnt(8)
    v_mfma_f32_32x32x16_bf16 v[16:31], v[116:119], v[164:167], v[16:31]
    s_waitcnt vmcnt(6)
    ds_read_b64_tr_b16 v[96:97], v252 offset:51200
    ds_read_b64_tr_b16 v[98:99], v252 offset:52480
    ds_read_b64_tr_b16 v[100:101], v252 offset:51208
    s_waitcnt lgkmcnt(9)
    v_mfma_f32_32x32x16_bf16 v[32:47], v[120:123], v[164:167], v[32:47]
    ds_read_b64_tr_b16 v[102:103], v252 offset:52488
    ds_read_b64_tr_b16 v[104:105], v252 offset:51216
    ds_read_b64_tr_b16 v[106:107], v252 offset:52496
    s_waitcnt lgkmcnt(6)
    s_add_u32 m0, s29, 0
    s_nop 0
    buffer_load_dwordx4 v232, s[92:95], s39 offen offset:0 lds
    v_mfma_f32_32x32x16_bf16 v[48:63], v[124:127], v[164:167], v[48:63]
    ds_read_b64_tr_b16 v[108:109], v252 offset:51224
    ds_read_b64_tr_b16 v[110:111], v252 offset:52504
    buffer_load_dwordx4 v233, s[92:95], s39 offen offset:1024 lds
    v_mfma_f32_32x32x16_bf16 v[64:79], v[128:131], v[164:167], v[64:79]
    ds_read_b64_tr_b16 v[112:113], v252 offset:51232
    ds_read_b64_tr_b16 v[114:115], v252 offset:52512
    buffer_load_dwordx4 v234, s[92:95], s39 offen offset:2048 lds
    buffer_load_dwordx4 v235, s[92:95], s39 offen offset:3072 lds
    v_mfma_f32_32x32x16_bf16 v[80:95], v[132:135], v[164:167], v[80:95]
    s_add_u32 m0, s29, 4096
    s_nop 0
    buffer_load_dwordx4 v236, s[92:95], s39 offen lds
    s_add_u32 s39, s39, 20480
    s_waitcnt lgkmcnt(8)
    v_mfma_f32_32x32x16_bf16 v[16:31], v[96:99], v[168:171], v[16:31]
    s_waitcnt vmcnt(5)
    ds_read_b64_tr_b16 v[116:117], v252 offset:25600
    ds_read_b64_tr_b16 v[118:119], v252 offset:26880
    ds_read_b64_tr_b16 v[120:121], v252 offset:25608
    s_waitcnt lgkmcnt(9)
    v_mfma_f32_32x32x16_bf16 v[32:47], v[100:103], v[168:171], v[32:47]
    ds_read_b64_tr_b16 v[122:123], v252 offset:26888
    ds_read_b64_tr_b16 v[124:125], v252 offset:25616
    ds_read_b64_tr_b16 v[126:127], v252 offset:26896
    s_waitcnt lgkmcnt(6)
    s_add_u32 m0, s29, 51200
    s_nop 0
    buffer_load_dwordx4 v232, s[92:95], s39 offen offset:0 lds
    v_mfma_f32_32x32x16_bf16 v[48:63], v[104:107], v[168:171], v[48:63]
    ds_read_b64_tr_b16 v[128:129], v252 offset:25624
    ds_read_b64_tr_b16 v[130:131], v252 offset:26904
    buffer_load_dwordx4 v233, s[92:95], s39 offen offset:1024 lds
    v_mfma_f32_32x32x16_bf16 v[64:79], v[108:111], v[168:171], v[64:79]
    ds_read_b64_tr_b16 v[132:133], v252 offset:25632
    ds_read_b64_tr_b16 v[134:135], v252 offset:26912
    buffer_load_dwordx4 v234, s[92:95], s39 offen offset:2048 lds
    buffer_load_dwordx4 v235, s[92:95], s39 offen offset:3072 lds
    v_mfma_f32_32x32x16_bf16 v[80:95], v[112:115], v[168:171], v[80:95]
    s_add_u32 m0, s29, 55296
    s_nop 0
    buffer_load_dwordx4 v236, s[92:95], s39 offen lds
    s_add_u32 s39, s39, 204800
    s_sub_u32 s60, s39, 1966080
    s_cmp_ge_u32 s39, 1966080
    s_cselect_b32 s39, s60, s39
    s_waitcnt lgkmcnt(8)
    v_mfma_f32_32x32x16_bf16 v[16:31], v[116:119], v[172:175], v[16:31]
    s_waitcnt vmcnt(5)
    ds_read_b64_tr_b16 v[96:97], v252 offset:0
    ds_read_b64_tr_b16 v[98:99], v252 offset:1280
    ds_read_b64_tr_b16 v[100:101], v252 offset:8
    s_waitcnt lgkmcnt(9)
    v_mfma_f32_32x32x16_bf16 v[32:47], v[120:123], v[172:175], v[32:47]
    ds_read_b64_tr_b16 v[102:103], v252 offset:1288
    ds_read_b64_tr_b16 v[104:105], v252 offset:16
    ds_read_b64_tr_b16 v[106:107], v252 offset:1296
    s_waitcnt lgkmcnt(6)
    s_add_u32 m0, s29, 25600
    s_nop 0
    buffer_load_dwordx4 v232, s[92:95], s39 offen offset:0 lds
    v_mfma_f32_32x32x16_bf16 v[48:63], v[124:127], v[172:175], v[48:63]
    ds_read_b64_tr_b16 v[108:109], v252 offset:24
    ds_read_b64_tr_b16 v[110:111], v252 offset:1304
    buffer_load_dwordx4 v233, s[92:95], s39 offen offset:1024 lds
    v_mfma_f32_32x32x16_bf16 v[64:79], v[128:131], v[172:175], v[64:79]
    ds_read_b64_tr_b16 v[112:113], v252 offset:32
    ds_read_b64_tr_b16 v[114:115], v252 offset:1312
    buffer_load_dwordx4 v234, s[92:95], s39 offen offset:2048 lds
    buffer_load_dwordx4 v235, s[92:95], s39 offen offset:3072 lds
    v_mfma_f32_32x32x16_bf16 v[80:95], v[132:135], v[172:175], v[80:95]
    s_add_u32 m0, s29, 29696
    s_nop 0
    buffer_load_dwordx4 v236, s[92:95], s39 offen lds
    s_add_u32 s39, s39, 20480
    s_waitcnt lgkmcnt(8)
    v_mfma_f32_32x32x16_bf16 v[16:31], v[96:99], v[176:179], v[16:31]
    s_waitcnt vmcnt(5)
    ds_read_b64_tr_b16 v[116:117], v252 offset:51200
    ds_read_b64_tr_b16 v[118:119], v252 offset:52480
    ds_read_b64_tr_b16 v[120:121], v252 offset:51208
    s_waitcnt lgkmcnt(9)
    v_mfma_f32_32x32x16_bf16 v[32:47], v[100:103], v[176:179], v[32:47]
    ds_read_b64_tr_b16 v[122:123], v252 offset:52488
    ds_read_b64_tr_b16 v[124:125], v252 offset:51216
    ds_read_b64_tr_b16 v[126:127], v252 offset:52496
    s_waitcnt lgkmcnt(6)
    s_add_u32 m0, s29, 0
    s_nop 0
    buffer_load_dwordx4 v232, s[92:95], s39 offen offset:0 lds
    v_mfma_f32_32x32x16_bf16 v[48:63], v[104:107], v[176:179], v[48:63]
    ds_read_b64_tr_b16 v[128:129], v252 offset:51224
    ds_read_b64_tr_b16 v[130:131], v252 offset:52504
    buffer_load_dwordx4 v233, s[92:95], s39 offen offset:1024 lds
    v_mfma_f32_32x32x16_bf16 v[64:79], v[108:111], v[176:179], v[64:79]
    ds_read_b64_tr_b16 v[132:133], v252 offset:51232
    ds_read_b64_tr_b16 v[134:135], v252 offset:52512
    buffer_load_dwordx4 v234, s[92:95], s39 offen offset:2048 lds
    buffer_load_dwordx4 v235, s[92:95], s39 offen offset:3072 lds
    v_mfma_f32_32x32x16_bf16 v[80:95], v[112:115], v[176:179], v[80:95]
    s_add_u32 m0, s29, 4096
    s_nop 0
    buffer_load_dwordx4 v236, s[92:95], s39 offen lds
    s_add_u32 s39, s39, 20480
    s_waitcnt lgkmcnt(8)
    v_mfma_f32_32x32x16_bf16 v[16:31], v[116:119], v[180:183], v[16:31]
    s_waitcnt vmcnt(5)
    ds_read_b64_tr_b16 v[96:97], v252 offset:25600
    ds_read_b64_tr_b16 v[98:99], v252 offset:26880
    ds_read_b64_tr_b16 v[100:101], v252 offset:25608
    s_waitcnt lgkmcnt(9)
    v_mfma_f32_32x32x16_bf16 v[32:47], v[120:123], v[180:183], v[32:47]
    ds_read_b64_tr_b16 v[102:103], v252 offset:26888
    ds_read_b64_tr_b16 v[104:105], v252 offset:25616
    ds_read_b64_tr_b16 v[106:107], v252 offset:26896
    s_waitcnt lgkmcnt(6)
    s_add_u32 m0, s29, 51200
    s_nop 0
    buffer_load_dwordx4 v232, s[92:95], s39 offen offset:0 lds
    v_mfma_f32_32x32x16_bf16 v[48:63], v[124:127], v[180:183], v[48:63]
    ds_read_b64_tr_b16 v[108:109], v252 offset:25624
    ds_read_b64_tr_b16 v[110:111], v252 offset:26904
    buffer_load_dwordx4 v233, s[92:95], s39 offen offset:1024 lds
    v_mfma_f32_32x32x16_bf16 v[64:79], v[128:131], v[180:183], v[64:79]
    ds_read_b64_tr_b16 v[112:113], v252 offset:25632
    ds_read_b64_tr_b16 v[114:115], v252 offset:26912
    buffer_load_dwordx4 v234, s[92:95], s39 offen offset:2048 lds
    buffer_load_dwordx4 v235, s[92:95], s39 offen offset:3072 lds
    v_mfma_f32_32x32x16_bf16 v[80:95], v[132:135], v[180:183], v[80:95]
    s_add_u32 m0, s29, 55296
    s_nop 0
    buffer_load_dwordx4 v236, s[92:95], s39 offen lds
    s_add_u32 s39, s39, 204800
    s_sub_u32 s60, s39, 1966080
    s_cmp_ge_u32 s39, 1966080
    s_cselect_b32 s39, s60, s39
    s_waitcnt lgkmcnt(8)
    v_mfma_f32_32x32x16_bf16 v[16:31], v[96:99], v[184:187], v[16:31]
    s_waitcnt vmcnt(5)
    ds_read_b64_tr_b16 v[116:117], v252 offset:0
    ds_read_b64_tr_b16 v[118:119], v252 offset:1280
    ds_read_b64_tr_b16 v[120:121], v252 offset:8
    s_waitcnt lgkmcnt(9)
    v_mfma_f32_32x32x16_bf16 v[32:47], v[100:103], v[184:187], v[32:47]
    ds_read_b64_tr_b16 v[122:123], v252 offset:1288
    ds_read_b64_tr_b16 v[124:125], v252 offset:16
    ds_read_b64_tr_b16 v[126:127], v252 offset:1296
    s_waitcnt lgkmcnt(6)
    s_add_u32 m0, s29, 25600
    s_nop 0
    buffer_load_dwordx4 v232, s[92:95], s39 offen offset:0 lds
    v_mfma_f32_32x32x16_bf16 v[48:63], v[104:107], v[184:187], v[48:63]
    ds_read_b64_tr_b16 v[128:129], v252 offset:24
    ds_read_b64_tr_b16 v[130:131], v252 offset:1304
    buffer_load_dwordx4 v233, s[92:95], s39 offen offset:1024 lds
    v_mfma_f32_32x32x16_bf16 v[64:79], v[108:111], v[184:187], v[64:79]
    ds_read_b64_tr_b16 v[132:133], v252 offset:32
    ds_read_b64_tr_b16 v[134:135], v252 offset:1312
    buffer_load_dwordx4 v234, s[92:95], s39 offen offset:2048 lds
    buffer_load_dwordx4 v235, s[92:95], s39 offen offset:3072 lds
    v_mfma_f32_32x32x16_bf16 v[80:95], v[112:115], v[184:187], v[80:95]
    s_add_u32 m0, s29, 29696
    s_nop 0
    buffer_load_dwordx4 v236, s[92:95], s39 offen lds
    s_add_u32 s39, s39, 20480
    s_waitcnt lgkmcnt(8)
    v_mfma_f32_32x32x16_bf16 v[16:31], v[116:119], v[188:191], v[16:31]
    s_waitcnt vmcnt(5)
    ds_read_b64_tr_b16 v[96:97], v252 offset:51200
    ds_read_b64_tr_b16 v[98:99], v252 offset:52480
    ds_read_b64_tr_b16 v[100:101], v252 offset:51208
    s_waitcnt lgkmcnt(9)
    v_mfma_f32_32x32x16_bf16 v[32:47], v[120:123], v[188:191], v[32:47]
    ds_read_b64_tr_b16 v[102:103], v252 offset:52488
    ds_read_b64_tr_b16 v[104:105], v252 offset:51216
    ds_read_b64_tr_b16 v[106:107], v252 offset:52496
    s_waitcnt lgkmcnt(6)
    s_add_u32 m0, s29, 0
    s_nop 0
    buffer_load_dwordx4 v232, s[92:95], s39 offen offset:0 lds
    v_mfma_f32_32x32x16_bf16 v[48:63], v[124:127], v[188:191], v[48:63]
    ds_read_b64_tr_b16 v[108:109], v252 offset:51224
    ds_read_b64_tr_b16 v[110:111], v252 offset:52504
    buffer_load_dwordx4 v233, s[92:95], s39 offen offset:1024 lds
    v_mfma_f32_32x32x16_bf16 v[64:79], v[128:131], v[188:191], v[64:79]
    ds_read_b64_tr_b16 v[112:113], v252 offset:51232
    ds_read_b64_tr_b16 v[114:115], v252 offset:52512
    buffer_load_dwordx4 v234, s[92:95], s39 offen offset:2048 lds
    buffer_load_dwordx4 v235, s[92:95], s39 offen offset:3072 lds
    v_mfma_f32_32x32x16_bf16 v[80:95], v[132:135], v[188:191], v[80:95]
    s_add_u32 m0, s29, 4096
    s_nop 0
    buffer_load_dwordx4 v236, s[92:95], s39 offen lds
    s_add_u32 s39, s39, 20480
    s_waitcnt lgkmcnt(8)
    v_mfma_f32_32x32x16_bf16 v[16:31], v[96:99], v[192:195], v[16:31]
    s_waitcnt vmcnt(5)
    ds_read_b64_tr_b16 v[116:117], v252 offset:25600
    ds_read_b64_tr_b16 v[118:119], v252 offset:26880
    ds_read_b64_tr_b16 v[120:121], v252 offset:25608
    s_waitcnt lgkmcnt(9)
    v_mfma_f32_32x32x16_bf16 v[32:47], v[100:103], v[192:195], v[32:47]
    ds_read_b64_tr_b16 v[122:123], v252 offset:26888
    ds_read_b64_tr_b16 v[124:125], v252 offset:25616
    ds_read_b64_tr_b16 v[126:127], v252 offset:26896
    s_waitcnt lgkmcnt(6)
    s_add_u32 m0, s29, 51200
    s_nop 0
    buffer_load_dwordx4 v232, s[92:95], s39 offen offset:0 lds
    v_mfma_f32_32x32x16_bf16 v[48:63], v[104:107], v[192:195], v[48:63]
    ds_read_b64_tr_b16 v[128:129], v252 offset:25624
    ds_read_b64_tr_b16 v[130:131], v252 offset:26904
    buffer_load_dwordx4 v233, s[92:95], s39 offen offset:1024 lds
    v_mfma_f32_32x32x16_bf16 v[64:79], v[108:111], v[192:195], v[64:79]
    ds_read_b64_tr_b16 v[132:133], v252 offset:25632
    ds_read_b64_tr_b16 v[134:135], v252 offset:26912
    buffer_load_dwordx4 v234, s[92:95], s39 offen offset:2048 lds
    buffer_load_dwordx4 v235, s[92:95], s39 offen offset:3072 lds
    v_mfma_f32_32x32x16_bf16 v[80:95], v[112:115], v[192:195], v[80:95]
    s_add_u32 m0, s29, 55296
    s_nop 0
    buffer_load_dwordx4 v236, s[92:95], s39 offen lds
    s_add_u32 s39, s39, 204800
    s_sub_u32 s60, s39, 1966080
    s_cmp_ge_u32 s39, 1966080
    s_cselect_b32 s39, s60, s39
    s_waitcnt lgkmcnt(8)
    v_mfma_f32_32x32x16_bf16 v[16:31], v[116:119], v[196:199], v[16:31]
    s_waitcnt vmcnt(5)
    ds_read_b64_tr_b16 v[96:97], v252 offset:0
    ds_read_b64_tr_b16 v[98:99], v252 offset:1280
    ds_read_b64_tr_b16 v[100:101], v252 offset:8
    s_waitcnt lgkmcnt(9)
    v_mfma_f32_32x32x16_bf16 v[32:47], v[120:123], v[196:199], v[32:47]
    ds_read_b64_tr_b16 v[102:103], v252 offset:1288
    ds_read_b64_tr_b16 v[104:105], v252 offset:16
    ds_read_b64_tr_b16 v[106:107], v252 offset:1296
    s_waitcnt lgkmcnt(6)
    s_add_u32 m0, s29, 25600
    s_nop 0
    buffer_load_dwordx4 v232, s[92:95], s39 offen offset:0 lds
    v_mfma_f32_32x32x16_bf16 v[48:63], v[124:127], v[196:199], v[48:63]
    ds_read_b64_tr_b16 v[108:109], v252 offset:24
    ds_read_b64_tr_b16 v[110:111], v252 offset:1304
    buffer_load_dwordx4 v233, s[92:95], s39 offen offset:1024 lds
    v_mfma_f32_32x32x16_bf16 v[64:79], v[128:131], v[196:199], v[64:79]
    ds_read_b64_tr_b16 v[112:113], v252 offset:32
    ds_read_b64_tr_b16 v[114:115], v252 offset:1312
    buffer_load_dwordx4 v234, s[92:95], s39 offen offset:2048 lds
    buffer_load_dwordx4 v235, s[92:95], s39 offen offset:3072 lds
    v_mfma_f32_32x32x16_bf16 v[80:95], v[132:135], v[196:199], v[80:95]
    s_add_u32 m0, s29, 29696
    s_nop 0
    buffer_load_dwordx4 v236, s[92:95], s39 offen lds
    s_add_u32 s39, s39, 20480
    s_waitcnt lgkmcnt(8)
    v_mfma_f32_32x32x16_bf16 v[16:31], v[96:99], v[200:203], v[16:31]
    s_waitcnt vmcnt(5)
    ds_read_b64_tr_b16 v[116:117], v252 offset:51200
    ds_read_b64_tr_b16 v[118:119], v252 offset:52480
    ds_read_b64_tr_b16 v[120:121], v252 offset:51208
    s_waitcnt lgkmcnt(9)
    v_mfma_f32_32x32x16_bf16 v[32:47], v[100:103], v[200:203], v[32:47]
    ds_read_b64_tr_b16 v[122:123], v252 offset:52488
    ds_read_b64_tr_b16 v[124:125], v252 offset:51216
    ds_read_b64_tr_b16 v[126:127], v252 offset:52496
    s_waitcnt lgkmcnt(6)
    s_add_u32 m0, s29, 0
    s_nop 0
    buffer_load_dwordx4 v232, s[92:95], s39 offen offset:0 lds
    v_mfma_f32_32x32x16_bf16 v[48:63], v[104:107], v[200:203], v[48:63]
    ds_read_b64_tr_b16 v[128:129], v252 offset:51224
    ds_read_b64_tr_b16 v[130:131], v252 offset:52504
    buffer_load_dwordx4 v233, s[92:95], s39 offen offset:1024 lds
    v_mfma_f32_32x32x16_bf16 v[64:79], v[108:111], v[200:203], v[64:79]
    ds_read_b64_tr_b16 v[132:133], v252 offset:51232
    ds_read_b64_tr_b16 v[134:135], v252 offset:52512
    buffer_load_dwordx4 v234, s[92:95], s39 offen offset:2048 lds
    buffer_load_dwordx4 v235, s[92:95], s39 offen offset:3072 lds
    v_mfma_f32_32x32x16_bf16 v[80:95], v[112:115], v[200:203], v[80:95]
    s_add_u32 m0, s29, 4096
    s_nop 0
    buffer_load_dwordx4 v236, s[92:95], s39 offen lds
    s_add_u32 s39, s39, 20480
    s_waitcnt lgkmcnt(8)
    v_mfma_f32_32x32x16_bf16 v[16:31], v[116:119], v[204:207], v[16:31]
    s_waitcnt vmcnt(5)
    ds_read_b64_tr_b16 v[96:97], v252 offset:25600
    ds_read_b64_tr_b16 v[98:99], v252 offset:26880
    ds_read_b64_tr_b16 v[100:101], v252 offset:25608
    s_waitcnt lgkmcnt(9)
    v_mfma_f32_32x32x16_bf16 v[32:47], v[120:123], v[204:207], v[32:47]
    ds_read_b64_tr_b16 v[102:103], v252 offset:26888
    ds_read_b64_tr_b16 v[104:105], v252 offset:25616
    ds_read_b64_tr_b16 v[106:107], v252 offset:26896
    s_waitcnt lgkmcnt(6)
    s_add_u32 m0, s29, 51200
    s_nop 0
    buffer_load_dwordx4 v232, s[92:95], s39 offen offset:0 lds
    v_mfma_f32_32x32x16_bf16 v[48:63], v[124:127], v[204:207], v[48:63]
    ds_read_b64_tr_b16 v[108:109], v252 offset:25624
    ds_read_b64_tr_b16 v[110:111], v252 offset:26904
    buffer_load_dwordx4 v233, s[92:95], s39 offen offset:1024 lds
    v_mfma_f32_32x32x16_bf16 v[64:79], v[128:131], v[204:207], v[64:79]
    ds_read_b64_tr_b16 v[112:113], v252 offset:25632
    ds_read_b64_tr_b16 v[114:115], v252 offset:26912
    buffer_load_dwordx4 v234, s[92:95], s39 offen offset:2048 lds
    buffer_load_dwordx4 v235, s[92:95], s39 offen offset:3072 lds
    v_mfma_f32_32x32x16_bf16 v[80:95], v[132:135], v[204:207], v[80:95]
    s_add_u32 m0, s29, 55296
    s_nop 0
    buffer_load_dwordx4 v236, s[92:95], s39 offen lds
    s_add_u32 s39, s39, 204800
    s_sub_u32 s60, s39, 1966080
    s_cmp_ge_u32 s39, 1966080
    s_cselect_b32 s39, s60, s39
    s_waitcnt lgkmcnt(8)
    v_mfma_f32_32x32x16_bf16 v[16:31], v[96:99], v[208:211], v[16:31]
    s_waitcnt vmcnt(5)
    ds_read_b64_tr_b16 v[116:117], v252 offset:0
    ds_read_b64_tr_b16 v[118:119], v252 offset:1280
    ds_read_b64_tr_b16 v[120:121], v252 offset:8
    s_waitcnt lgkmcnt(9)
    v_mfma_f32_32x32x16_bf16 v[32:47], v[100:103], v[208:211], v[32:47]
    ds_read_b64_tr_b16 v[122:123], v252 offset:1288
    ds_read_b64_tr_b16 v[124:125], v252 offset:16
    ds_read_b64_tr_b16 v[126:127], v252 offset:1296
    s_waitcnt lgkmcnt(6)
    s_add_u32 m0, s29, 25600
    s_nop 0
    buffer_load_dwordx4 v232, s[92:95], s39 offen offset:0 lds
    v_mfma_f32_32x32x16_bf16 v[48:63], v[104:107], v[208:211], v[48:63]
    ds_read_b64_tr_b16 v[128:129], v252 offset:24
    ds_read_b64_tr_b16 v[130:131], v252 offset:1304
    buffer_load_dwordx4 v233, s[92:95], s39 offen offset:1024 lds
    v_mfma_f32_32x32x16_bf16 v[64:79], v[108:111], v[208:211], v[64:79]
    ds_read_b64_tr_b16 v[132:133], v252 offset:32
    ds_read_b64_tr_b16 v[134:135], v252 offset:1312
    buffer_load_dwordx4 v234, s[92:95], s39 offen offset:2048 lds
    buffer_load_dwordx4 v235, s[92:95], s39 offen offset:3072 lds
    v_mfma_f32_32x32x16_bf16 v[80:95], v[112:115], v[208:211], v[80:95]
    s_add_u32 m0, s29, 29696
    s_nop 0
    buffer_load_dwordx4 v236, s[92:95], s39 offen lds
    s_add_u32 s39, s39, 20480
    s_waitcnt lgkmcnt(8)
    v_mfma_f32_32x32x16_bf16 v[16:31], v[116:119], v[212:215], v[16:31]
    s_waitcnt vmcnt(5)
    ds_read_b64_tr_b16 v[96:97], v252 offset:51200
    ds_read_b64_tr_b16 v[98:99], v252 offset:52480
    ds_read_b64_tr_b16 v[100:101], v252 offset:51208
    s_waitcnt lgkmcnt(9)
    v_mfma_f32_32x32x16_bf16 v[32:47], v[120:123], v[212:215], v[32:47]
    ds_read_b64_tr_b16 v[102:103], v252 offset:52488
    ds_read_b64_tr_b16 v[104:105], v252 offset:51216
    ds_read_b64_tr_b16 v[106:107], v252 offset:52496
    s_waitcnt lgkmcnt(6)
    s_add_u32 m0, s29, 0
    s_nop 0
    buffer_load_dwordx4 v232, s[92:95], s39 offen offset:0 lds
    v_mfma_f32_32x32x16_bf16 v[48:63], v[124:127], v[212:215], v[48:63]
    ds_read_b64_tr_b16 v[108:109], v252 offset:51224
    ds_read_b64_tr_b16 v[110:111], v252 offset:52504
    buffer_load_dwordx4 v233, s[92:95], s39 offen offset:1024 lds
    v_mfma_f32_32x32x16_bf16 v[64:79], v[128:131], v[212:215], v[64:79]
    ds_read_b64_tr_b16 v[112:113], v252 offset:51232
    ds_read_b64_tr_b16 v[114:115], v252 offset:52512
    buffer_load_dwordx4 v234, s[92:95], s39 offen offset:2048 lds
    buffer_load_dwordx4 v235, s[92:95], s39 offen offset:3072 lds
    v_mfma_f32_32x32x16_bf16 v[80:95], v[132:135], v[212:215], v[80:95]
    s_add_u32 m0, s29, 4096
    s_nop 0
    buffer_load_dwordx4 v236, s[92:95], s39 offen lds
    s_add_u32 s39, s39, 20480
    s_waitcnt lgkmcnt(8)
    v_mfma_f32_32x32x16_bf16 v[16:31], v[96:99], v[216:219], v[16:31]
    s_waitcnt vmcnt(5)
    ds_read_b64_tr_b16 v[116:117], v252 offset:25600
    ds_read_b64_tr_b16 v[118:119], v252 offset:26880
    ds_read_b64_tr_b16 v[120:121], v252 offset:25608
    s_waitcnt lgkmcnt(9)
    v_mfma_f32_32x32x16_bf16 v[32:47], v[100:103], v[216:219], v[32:47]
    ds_read_b64_tr_b16 v[122:123], v252 offset:26888
    ds_read_b64_tr_b16 v[124:125], v252 offset:25616
    ds_read_b64_tr_b16 v[126:127], v252 offset:26896
    s_waitcnt lgkmcnt(6)
    s_add_u32 m0, s29, 51200
    s_nop 0
    buffer_load_dwordx4 v232, s[92:95], s39 offen offset:0 lds
    v_mfma_f32_32x32x16_bf16 v[48:63], v[104:107], v[216:219], v[48:63]
    ds_read_b64_tr_b16 v[128:129], v252 offset:25624
    ds_read_b64_tr_b16 v[130:131], v252 offset:26904
    buffer_load_dwordx4 v233, s[92:95], s39 offen offset:1024 lds
    v_mfma_f32_32x32x16_bf16 v[64:79], v[108:111], v[216:219], v[64:79]
    ds_read_b64_tr_b16 v[132:133], v252 offset:25632
    ds_read_b64_tr_b16 v[134:135], v252 offset:26912
    buffer_load_dwordx4 v234, s[92:95], s39 offen offset:2048 lds
    buffer_load_dwordx4 v235, s[92:95], s39 offen offset:3072 lds
    v_mfma_f32_32x32x16_bf16 v[80:95], v[112:115], v[216:219], v[80:95]
    s_add_u32 m0, s29, 55296
    s_nop 0
    buffer_load_dwordx4 v236, s[92:95], s39 offen lds
    s_add_u32 s39, s39, 204800
    s_sub_u32 s60, s39, 1966080
    s_cmp_ge_u32 s39, 1966080
    s_cselect_b32 s39, s60, s39
    s_waitcnt lgkmcnt(8)
    v_mfma_f32_32x32x16_bf16 v[16:31], v[116:119], v[220:223], v[16:31]
    s_waitcnt vmcnt(5)
    ds_read_b64_tr_b16 v[96:97], v252 offset:0
    ds_read_b64_tr_b16 v[98:99], v252 offset:1280
    ds_read_b64_tr_b16 v[100:101], v252 offset:8
    s_waitcnt lgkmcnt(9)
    v_mfma_f32_32x32x16_bf16 v[32:47], v[120:123], v[220:223], v[32:47]
    ds_read_b64_tr_b16 v[102:103], v252 offset:1288
    ds_read_b64_tr_b16 v[104:105], v252 offset:16
    ds_read_b64_tr_b16 v[106:107], v252 offset:1296
    s_waitcnt lgkmcnt(6)
    s_add_u32 m0, s29, 25600
    s_nop 0
    buffer_load_dwordx4 v232, s[96:99], s40 offen offset:0 lds
    v_mfma_f32_32x32x16_bf16 v[48:63], v[124:127], v[220:223], v[48:63]
    ds_read_b64_tr_b16 v[108:109], v252 offset:24
    ds_read_b64_tr_b16 v[110:111], v252 offset:1304
    buffer_load_dwordx4 v233, s[96:99], s40 offen offset:1024 lds
    v_mfma_f32_32x32x16_bf16 v[64:79], v[128:131], v[220:223], v[64:79]
    ds_read_b64_tr_b16 v[112:113], v252 offset:32
    ds_read_b64_tr_b16 v[114:115], v252 offset:1312
    buffer_load_dwordx4 v234, s[96:99], s40 offen offset:2048 lds
    buffer_load_dwordx4 v235, s[96:99], s40 offen offset:3072 lds
    v_mfma_f32_32x32x16_bf16 v[80:95], v[132:135], v[220:223], v[80:95]
    s_add_u32 m0, s29, 29696
    s_nop 0
    buffer_load_dwordx4 v236, s[96:99], s40 offen lds
    s_add_u32 s40, s40, 25600
    s_waitcnt lgkmcnt(8)
    v_mfma_f32_32x32x16_bf16 v[16:31], v[96:99], v[224:227], v[16:31]
    s_waitcnt vmcnt(5)
    ds_read_b64_tr_b16 v[116:117], v252 offset:51200
    ds_read_b64_tr_b16 v[118:119], v252 offset:52480
    ds_read_b64_tr_b16 v[120:121], v252 offset:51208
    s_waitcnt lgkmcnt(9)
    v_mfma_f32_32x32x16_bf16 v[32:47], v[100:103], v[224:227], v[32:47]
    ds_read_b64_tr_b16 v[122:123], v252 offset:52488
    ds_read_b64_tr_b16 v[124:125], v252 offset:51216
    ds_read_b64_tr_b16 v[126:127], v252 offset:52496
    s_waitcnt lgkmcnt(6)
    s_add_u32 m0, s29, 0
    s_nop 0
    buffer_load_dwordx4 v232, s[96:99], s40 offen offset:0 lds
    v_mfma_f32_32x32x16_bf16 v[48:63], v[104:107], v[224:227], v[48:63]
    ds_read_b64_tr_b16 v[128:129], v252 offset:51224
    ds_read_b64_tr_b16 v[130:131], v252 offset:52504
    buffer_load_dwordx4 v233, s[96:99], s40 offen offset:1024 lds
    v_mfma_f32_32x32x16_bf16 v[64:79], v[108:111], v[224:227], v[64:79]
    ds_read_b64_tr_b16 v[132:133], v252 offset:51232
    ds_read_b64_tr_b16 v[134:135], v252 offset:52512
    buffer_load_dwordx4 v234, s[96:99], s40 offen offset:2048 lds
    buffer_load_dwordx4 v235, s[96:99], s40 offen offset:3072 lds
    v_mfma_f32_32x32x16_bf16 v[80:95], v[112:115], v[224:227], v[80:95]
    s_add_u32 m0, s29, 4096
    s_nop 0
    buffer_load_dwordx4 v236, s[96:99], s40 offen lds
    s_add_u32 s40, s40, 25600
    s_waitcnt lgkmcnt(8)
    v_mfma_f32_32x32x16_bf16 v[16:31], v[116:119], v[228:231], v[16:31]
    s_waitcnt vmcnt(5)
    ds_read_b64_tr_b16 v[96:97], v252 offset:25600
    ds_read_b64_tr_b16 v[98:99], v252 offset:26880
    ds_read_b64_tr_b16 v[100:101], v252 offset:25608
    s_waitcnt lgkmcnt(9)
    v_mfma_f32_32x32x16_bf16 v[32:47], v[120:123], v[228:231], v[32:47]
    ds_read_b64_tr_b16 v[102:103], v252 offset:26888
    ds_read_b64_tr_b16 v[104:105], v252 offset:25616
    ds_read_b64_tr_b16 v[106:107], v252 offset:26896
    s_waitcnt lgkmcnt(6)
    s_add_u32 m0, s29, 51200
    s_nop 0
    buffer_load_dwordx4 v232, s[96:99], s40 offen offset:0 lds
    v_mfma_f32_32x32x16_bf16 v[48:63], v[124:127], v[228:231], v[48:63]
    ds_read_b64_tr_b16 v[108:109], v252 offset:25624
    ds_read_b64_tr_b16 v[110:111], v252 offset:26904
    buffer_load_dwordx4 v233, s[96:99], s40 offen offset:1024 lds
    v_mfma_f32_32x32x16_bf16 v[64:79], v[128:131], v[228:231], v[64:79]
    ds_read_b64_tr_b16 v[112:113], v252 offset:25632
    ds_read_b64_tr_b16 v[114:115], v252 offset:26912
    buffer_load_dwordx4 v234, s[96:99], s40 offen offset:2048 lds
    buffer_load_dwordx4 v235, s[96:99], s40 offen offset:3072 lds
    v_mfma_f32_32x32x16_bf16 v[80:95], v[132:135], v[228:231], v[80:95]
    s_add_u32 m0, s29, 55296
    s_nop 0
    buffer_load_dwordx4 v236, s[96:99], s40 offen lds
    s_add_u32 s40, s40, 25600
    s_waitcnt vmcnt(5)
    ds_read_b64_tr_b16 v[116:117], v252 offset:0
    ds_read_b64_tr_b16 v[118:119], v252 offset:1280
    ds_read_b64_tr_b16 v[120:121], v252 offset:8
    ds_read_b64_tr_b16 v[122:123], v252 offset:1288
    ds_read_b64_tr_b16 v[124:125], v252 offset:16
    ds_read_b64_tr_b16 v[126:127], v252 offset:1296
    ds_read_b64_tr_b16 v[128:129], v252 offset:24
    ds_read_b64_tr_b16 v[130:131], v252 offset:1304
    ds_read_b64_tr_b16 v[132:133], v252 offset:32
    ds_read_b64_tr_b16 v[134:135], v252 offset:1312
    s_waitcnt vmcnt(0)
    ds_read_b64_tr_b16 v[176:177], v252 offset:51200
    ds_read_b64_tr_b16 v[178:179], v252 offset:52480
    ds_read_b64_tr_b16 v[180:181], v252 offset:51208
    ds_read_b64_tr_b16 v[182:183], v252 offset:52488
    ds_read_b64_tr_b16 v[184:185], v252 offset:51216
    ds_read_b64_tr_b16 v[186:187], v252 offset:52496
    ds_read_b64_tr_b16 v[188:189], v252 offset:51224
    ds_read_b64_tr_b16 v[190:191], v252 offset:52504
    ds_read_b64_tr_b16 v[192:193], v252 offset:51232
    ds_read_b64_tr_b16 v[194:195], v252 offset:52512
    s_waitcnt lgkmcnt(15)
    s_add_u32 m0, s29, 25600
    s_nop 0
    buffer_load_dwordx4 v232, s[96:99], s40 offen offset:0 lds
    buffer_load_dwordx4 v233, s[96:99], s40 offen offset:1024 lds
    buffer_load_dwordx4 v234, s[96:99], s40 offen offset:2048 lds
    buffer_load_dwordx4 v235, s[96:99], s40 offen offset:3072 lds
    s_add_u32 m0, s29, 29696
    s_nop 0
    buffer_load_dwordx4 v236, s[96:99], s40 offen lds
    s_add_u32 s40, s40, 25600
    s_waitcnt lgkmcnt(10)
    s_add_u32 m0, s29, 0
    s_nop 0
    buffer_load_dwordx4 v232, s[96:99], s40 offen offset:0 lds
    buffer_load_dwordx4 v233, s[96:99], s40 offen offset:1024 lds
    buffer_load_dwordx4 v234, s[96:99], s40 offen offset:2048 lds
    buffer_load_dwordx4 v235, s[96:99], s40 offen offset:3072 lds
    s_add_u32 m0, s29, 4096
    s_nop 0
    buffer_load_dwordx4 v236, s[96:99], s40 offen lds
    s_add_u32 s40, s40, 25600
    s_waitcnt lgkmcnt(0)
    s_add_u32 m0, s29, 51200
    s_nop 0
    buffer_load_dwordx4 v232, s[96:99], s40 offen offset:0 lds
    buffer_load_dwordx4 v233, s[96:99], s40 offen offset:1024 lds
    buffer_load_dwordx4 v234, s[96:99], s40 offen offset:2048 lds
    buffer_load_dwordx4 v235, s[96:99], s40 offen offset:3072 lds
    s_add_u32 m0, s29, 55296
    s_nop 0
    buffer_load_dwordx4 v236, s[96:99], s40 offen lds
    s_add_u32 s40, s40, 25600
    s_waitcnt vmcnt(10)
    ds_read_b64_tr_b16 v[196:197], v252 offset:25600
    ds_read_b64_tr_b16 v[198:199], v252 offset:26880
    ds_read_b64_tr_b16 v[200:201], v252 offset:25608
    ds_read_b64_tr_b16 v[202:203], v252 offset:26888
    ds_read_b64_tr_b16 v[204:205], v252 offset:25616
    ds_read_b64_tr_b16 v[206:207], v252 offset:26896
    ds_read_b64_tr_b16 v[208:209], v252 offset:25624
    ds_read_b64_tr_b16 v[210:211], v252 offset:26904
    ds_read_b64_tr_b16 v[212:213], v252 offset:25632
    ds_read_b64_tr_b16 v[214:215], v252 offset:26912
    s_waitcnt lgkmcnt(0)
    s_add_u32 m0, s29, 25600
    s_nop 0
    buffer_load_dwordx4 v232, s[96:99], s40 offen offset:0 lds
    buffer_load_dwordx4 v233, s[96:99], s40 offen offset:1024 lds
    buffer_load_dwordx4 v234, s[96:99], s40 offen offset:2048 lds
    buffer_load_dwordx4 v235, s[96:99], s40 offen offset:3072 lds
    s_add_u32 m0, s29, 29696
    s_nop 0
    buffer_load_dwordx4 v236, s[96:99], s40 offen lds
    s_add_u32 s40, s40, 25600
    s_setprio 3
    s_add_u32 s30, s36, 4096
    s_add_u32 s31, s36, 8192
    buffer_load_dwordx4 v[136:139], v2, s[12:15], s36 offen offset:0 sc1
    buffer_load_dwordx4 v[140:143], v2, s[12:15], s36 offen offset:1024 sc1
    buffer_load_dwordx4 v[144:147], v2, s[12:15], s36 offen offset:2048 sc1
    buffer_load_dwordx4 v[148:151], v2, s[12:15], s36 offen offset:3072 sc1
    buffer_load_dwordx4 v[152:155], v2, s[12:15], s30 offen offset:0 sc1
    buffer_load_dwordx4 v[156:159], v2, s[12:15], s30 offen offset:1024 sc1
    buffer_load_dwordx4 v[160:163], v2, s[12:15], s30 offen offset:2048 sc1
    buffer_load_dwordx4 v[164:167], v2, s[12:15], s30 offen offset:3072 sc1
    buffer_load_dwordx4 v[168:171], v2, s[12:15], s31 offen offset:0 sc1
    buffer_load_dwordx4 v[172:175], v2, s[12:15], s31 offen offset:1024 sc1
    s_waitcnt vmcnt(9)
    s_mov_b32 s63, 8192
L_ck_23:
    v_max3_u32 v3, v136, v137, v138
    v_max_u32 v3, v3, v139
    v_cmp_eq_u32 vcc, -1, v3
    s_cmp_eq_u64 vcc, 0
    s_cbranch_scc0 L_rt_24
L_go_25:
    v_mfma_f32_32x32x16_bf16 v[16:31], v[96:99], v[136:139], v[16:31]
    v_mfma_f32_32x32x16_bf16 v[32:47], v[100:103], v[136:139], v[32:47]
    v_mfma_f32_32x32x16_bf16 v[48:63], v[104:107], v[136:139], v[48:63]
    v_mfma_f32_32x32x16_bf16 v[64:79], v[108:111], v[136:139], v[64:79]
    v_mfma_f32_32x32x16_bf16 v[80:95], v[112:115], v[136:139], v[80:95]
    s_waitcnt vmcnt(8)
    s_mov_b32 s63, 8192
L_ck_26:
    v_max3_u32 v3, v140, v141, v142
    v_max_u32 v3, v3, v143
    v_cmp_eq_u32 vcc, -1, v3
    s_cmp_eq_u64 vcc, 0
    s_cbranch_scc0 L_rt_27
L_go_28:
    v_mfma_f32_32x32x16_bf16 v[16:31], v[116:119], v[140:143], v[16:31]
    ds_read_b64_tr_b16 v[96:97], v252 offset:0
    ds_read_b64_tr_b16 v[98:99], v252 offset:1280
    v_mfma_f32_32x32x16_bf16 v[32:47], v[120:123], v[140:143], v[32:47]
    ds_read_b64_tr_b16 v[100:101], v252 offset:8
    ds_read_b64_tr_b16 v[102:103], v252 offset:1288
    v_mfma_f32_32x32x16_bf16 v[48:63], v[124:127], v[140:143], v[48:63]
    ds_read_b64_tr_b16 v[104:105], v252 offset:16
    ds_read_b64_tr_b16 v[106:107], v252 offset:1296
    v_mfma_f32_32x32x16_bf16 v[64:79], v[128:131], v[140:143], v[64:79]
    ds_read_b64_tr_b16 v[108:109], v252 offset:24
    ds_read_b64_tr_b16 v[110:111], v252 offset:1304
    v_mfma_f32_32x32x16_bf16 v[80:95], v[132:135], v[140:143], v[80:95]
    ds_read_b64_tr_b16 v[112:113], v252 offset:32
    ds_read_b64_tr_b16 v[114:115], v252 offset:1312
    s_waitcnt vmcnt(7)
    s_mov_b32 s63, 8192
L_ck_29:
    v_max3_u32 v3, v144, v145, v146
    v_max_u32 v3, v3, v147
    v_cmp_eq_u32 vcc, -1, v3
    s_cmp_eq_u64 vcc, 0
    s_cbranch_scc0 L_rt_30
L_go_31:
    v_mfma_f32_32x32x16_bf16 v[16:31], v[176:179], v[144:147], v[16:31]
    ds_read_b64_tr_b16 v[116:117], v252 offset:51200
    ds_read_b64_tr_b16 v[118:119], v252 offset:52480
    v_mfma_f32_32x32x16_bf16 v[32:47], v[180:183], v[144:147], v[32:47]
    ds_read_b64_tr_b16 v[120:121], v252 offset:51208
    ds_read_b64_tr_b16 v[122:123], v252 offset:52488
    v_mfma_f32_32x32x16_bf16 v[48:63], v[184:187], v[144:147], v[48:63]
    ds_read_b64_tr_b16 v[124:125], v252 offset:51216
    ds_read_b64_tr_b16 v[126:127], v252 offset:52496
    v_mfma_f32_32x32x16_bf16 v[64:79], v[188:191], v[144:147], v[64:79]
    ds_read_b64_tr_b16 v[128:129], v252 offset:51224
    ds_read_b64_tr_b16 v[130:131], v252 offset:52504
    v_mfma_f32_32x32x16_bf16 v[80:95], v[192:195], v[144:147], v[80:95]
    ds_read_b64_tr_b16 v[132:133], v252 offset:51232
    ds_read_b64_tr_b16 v[134:135], v252 offset:52512
    s_waitcnt lgkmcnt(10)
    s_add_u32 m0, s29, 0
    s_nop 0
    buffer_load_dwordx4 v232, s[96:99], s40 offen offset:0 lds
    buffer_load_dwordx4 v233, s[96:99], s40 offen offset:1024 lds
    buffer_load_dwordx4 v234, s[96:99], s40 offen offset:2048 lds
    buffer_load_dwordx4 v235, s[96:99], s40 offen offset:3072 lds
    s_add_u32 m0, s29, 4096
    s_nop 0
    buffer_load_dwordx4 v236, s[96:99], s40 offen lds
    s_add_u32 s40, s40, 25600
    s_waitcnt vmcnt(11)
    s_mov_b32 s63, 8192
L_ck_32:
    v_max3_u32 v3, v148, v149, v150
    v_max_u32 v3, v3, v151
    v_cmp_eq_u32 vcc, -1, v3
    s_cmp_eq_u64 vcc, 0
    s_cbranch_scc0 L_rt_33
L_go_34:
    v_mfma_f32_32x32x16_bf16 v[16:31], v[196:199], v[148:151], v[16:31]
    ds_read_b64_tr_b16 v[176:177], v252 offset:25600
    ds_read_b64_tr_b16 v[178:179], v252 offset:26880
    v_mfma_f32_32x32x16_bf16 v[32:47], v[200:203], v[148:151], v[32:47]
    ds_read_b64_tr_b16 v[180:181], v252 offset:25608
    ds_read_b64_tr_b16 v[182:183], v252 offset:26888
    v_mfma_f32_32x32x16_bf16 v[48:63], v[204:207], v[148:151], v[48:63]
    ds_read_b64_tr_b16 v[184:185], v252 offset:25616
    ds_read_b64_tr_b16 v[186:187], v252 offset:26896
    v_mfma_f32_32x32x16_bf16 v[64:79], v[208:211], v[148:151], v[64:79]
    ds_read_b64_tr_b16 v[188:189], v252 offset:25624
    ds_read_b64_tr_b16 v[190:191], v252 offset:26904
    v_mfma_f32_32x32x16_bf16 v[80:95], v[212:215], v[148:151], v[80:95]
    ds_read_b64_tr_b16 v[192:193], v252 offset:25632
    ds_read_b64_tr_b16 v[194:195], v252 offset:26912
    s_waitcnt lgkmcnt(10)
    s_add_u32 m0, s29, 51200
    s_nop 0
    buffer_load_dwordx4 v237, s[96:99], s41 offen offset:0 lds
    buffer_load_dwordx4 v238, s[96:99], s41 offen offset:1024 lds
    buffer_load_dwordx4 v239, s[96:99], s41 offen offset:2048 lds
    buffer_load_dwordx4 v240, s[96:99], s41 offen offset:3072 lds
    s_add_u32 m0, s29, 55296
    s_nop 0
    buffer_load_dwordx4 v241, s[96:99], s41 offen lds
    s_add_u32 s41, s41, 102400
    s_waitcnt vmcnt(15)
    s_mov_b32 s63, 8192
L_ck_35:
    v_max3_u32 v3, v152, v153, v154
    v_max_u32 v3, v3, v155
    v_cmp_eq_u32 vcc, -1, v3
    s_cmp_eq_u64 vcc, 0
    s_cbranch_scc0 L_rt_36
L_go_37:
    v_mfma_f32_32x32x16_bf16 v[16:31], v[96:99], v[152:155], v[16:31]
    s_waitcnt vmcnt(5)
    ds_read_b64_tr_b16 v[196:197], v252 offset:0
    ds_read_b64_tr_b16 v[198:199], v252 offset:1280
    v_mfma_f32_32x32x16_bf16 v[32:47], v[100:103], v[152:155], v[32:47]
    ds_read_b64_tr_b16 v[200:201], v252 offset:8
    ds_read_b64_tr_b16 v[202:203], v252 offset:1288
    v_mfma_f32_32x32x16_bf16 v[48:63], v[104:107], v[152:155], v[48:63]
    ds_read_b64_tr_b16 v[204:205], v252 offset:16
    ds_read_b64_tr_b16 v[206:207], v252 offset:1296
    v_mfma_f32_32x32x16_bf16 v[64:79], v[108:111], v[152:155], v[64:79]
    ds_read_b64_tr_b16 v[208:209], v252 offset:24
    ds_read_b64_tr_b16 v[210:211], v252 offset:1304
    v_mfma_f32_32x32x16_bf16 v[80:95], v[112:115], v[152:155], v[80:95]
    ds_read_b64_tr_b16 v[212:213], v252 offset:32
    ds_read_b64_tr_b16 v[214:215], v252 offset:1312
    s_waitcnt lgkmcnt(10)
    s_add_u32 m0, s29, 25600
    s_nop 0
    buffer_load_dwordx4 v237, s[96:99], s41 offen offset:0 lds
    buffer_load_dwordx4 v238, s[96:99], s41 offen offset:1024 lds
    buffer_load_dwordx4 v239, s[96:99], s41 offen offset:2048 lds
    buffer_load_dwordx4 v240, s[96:99], s41 offen offset:3072 lds
    s_add_u32 m0, s29, 29696
    s_nop 0
    buffer_load_dwordx4 v241, s[96:99], s41 offen lds
    s_add_u32 s41, s41, 102400
    s_mov_b32 s63, 8192
L_ck_38:
    v_max3_u32 v3, v156, v157, v158
    v_max_u32 v3, v3, v159
    v_cmp_eq_u32 vcc, -1, v3
    s_cmp_eq_u64 vcc, 0
    s_cbranch_scc0 L_rt_39
L_go_40:
    v_mfma_f32_32x32x16_bf16 v[16:31], v[116:119], v[156:159], v[16:31]
    s_waitcnt vmcnt(5)
    ds_read_b64_tr_b16 v[96:97], v252 offset:51200
    ds_read_b64_tr_b16 v[98:99], v252 offset:52480
    v_mfma_f32_32x32x16_bf16 v[32:47], v[120:123], v[156:159], v[32:47]
    ds_read_b64_tr_b16 v[100:101], v252 offset:51208
    ds_read_b64_tr_b16 v[102:103], v252 offset:52488
    v_mfma_f32_32x32x16_bf16 v[48:63], v[124:127], v[156:159], v[48:63]
    ds_read_b64_tr_b16 v[104:105], v252 offset:51216
    ds_read_b64_tr_b16 v[106:107], v252 offset:52496
    v_mfma_f32_32x32x16_bf16 v[64:79], v[128:131], v[156:159], v[64:79]
    ds_read_b64_tr_b16 v[108:109], v252 offset:51224
    ds_read_b64_tr_b16 v[110:111], v252 offset:52504
    v_mfma_f32_32x32x16_bf16 v[80:95], v[132:135], v[156:159], v[80:95]
    ds_read_b64_tr_b16 v[112:113], v252 offset:51232
    ds_read_b64_tr_b16 v[114:115], v252 offset:52512
    s_mov_b32 s63, 8192
L_ck_41:
    v_max3_u32 v3, v160, v161, v162
    v_max_u32 v3, v3, v163
    v_cmp_eq_u32 vcc, -1, v3
    s_cmp_eq_u64 vcc, 0
    s_cbranch_scc0 L_rt_42
L_go_43:
    v_mfma_f32_32x32x16_bf16 v[16:31], v[176:179], v[160:163], v[16:31]
    s_waitcnt vmcnt(0)
    ds_read_b64_tr_b16 v[116:117], v252 offset:25600
    ds_read_b64_tr_b16 v[118:119], v252 offset:26880
    v_mfma_f32_32x32x16_bf16 v[32:47], v[180:183], v[160:163], v[32:47]
    ds_read_b64_tr_b16 v[120:121], v252 offset:25608
    ds_read_b64_tr_b16 v[122:123], v252 offset:26888
    v_mfma_f32_32x32x16_bf16 v[48:63], v[184:187], v[160:163], v[48:63]
    ds_read_b64_tr_b16 v[124:125], v252 offset:25616
    ds_read_b64_tr_b16 v[126:127], v252 offset:26896
    v_mfma_f32_32x32x16_bf16 v[64:79], v[188:191], v[160:163], v[64:79]
    ds_read_b64_tr_b16 v[128:129], v252 offset:25624
    ds_read_b64_tr_b16 v[130:131], v252 offset:26904
    v_mfma_f32_32x32x16_bf16 v[80:95], v[192:195], v[160:163], v[80:95]
    ds_read_b64_tr_b16 v[132:133], v252 offset:25632
    ds_read_b64_tr_b16 v[134:135], v252 offset:26912
    s_mov_b32 s63, 8192
L_ck_44:
    v_max3_u32 v3, v164, v165, v166
    v_max_u32 v3, v3, v167
    v_cmp_eq_u32 vcc, -1, v3
    s_cmp_eq_u64 vcc, 0
    s_cbranch_scc0 L_rt_45
L_go_46:
    s_waitcnt lgkmcnt(15)
    v_mfma_f32_32x32x16_bf16 v[16:31], v[196:199], v[164:167], v[16:31]
    v_mfma_f32_32x32x16_bf16 v[32:47], v[200:203], v[164:167], v[32:47]
    v_mfma_f32_32x32x16_bf16 v[48:63], v[204:207], v[164:167], v[48:63]
    v_mfma_f32_32x32x16_bf16 v[64:79], v[208:211], v[164:167], v[64:79]
    v_mfma_f32_32x32x16_bf16 v[80:95], v[212:215], v[164:167], v[80:95]
    s_mov_b32 s63, 8192
L_ck_47:
    v_max3_u32 v3, v168, v169, v170
    v_max_u32 v3, v3, v171
    v_cmp_eq_u32 vcc, -1, v3
    s_cmp_eq_u64 vcc, 0
    s_cbranch_scc0 L_rt_48
L_go_49:
    v_mfma_f32_32x32x16_bf16 v[16:31], v[96:99], v[168:171], v[16:31]
    v_mfma_f32_32x32x16_bf16 v[32:47], v[100:103], v[168:171], v[32:47]
    s_waitcnt lgkmcnt(14)
    v_mfma_f32_32x32x16_bf16 v[48:63], v[104:107], v[168:171], v[48:63]
    s_waitcnt lgkmcnt(12)
    v_mfma_f32_32x32x16_bf16 v[64:79], v[108:111], v[168:171], v[64:79]
    s_waitcnt lgkmcnt(10)
    v_mfma_f32_32x32x16_bf16 v[80:95], v[112:115], v[168:171], v[80:95]
    s_mov_b32 s63, 8192
L_ck_50:
    v_max3_u32 v3, v172, v173, v174
    v_max_u32 v3, v3, v175
    v_cmp_eq_u32 vcc, -1, v3
    s_cmp_eq_u64 vcc, 0
    s_cbranch_scc0 L_rt_51
L_go_52:
    s_waitcnt lgkmcnt(8)
    v_mfma_f32_32x32x16_bf16 v[16:31], v[116:119], v[172:175], v[16:31]
    s_waitcnt lgkmcnt(6)
    v_mfma_f32_32x32x16_bf16 v[32:47], v[120:123], v[172:175], v[32:47]
    s_waitcnt lgkmcnt(4)
    v_mfma_f32_32x32x16_bf16 v[48:63], v[124:127], v[172:175], v[48:63]
    s_waitcnt lgkmcnt(2)
    v_mfma_f32_32x32x16_bf16 v[64:79], v[128:131], v[172:175], v[64:79]
    s_waitcnt lgkmcnt(0)
    v_mfma_f32_32x32x16_bf16 v[80:95], v[132:135], v[172:175], v[80:95]
    s_mov_b32 s16, s82
    s_mov_b32 s17, s83
    s_mov_b32 s18, 2621440
    s_mov_b32 s19, 0x00020000
    v_add_u32 v3, s29, v2
    v_lshlrev_b32 v96, 16, v242
    v_and_b32 v97, 0xffff0000, v242
    v_lshlrev_b32 v98, 16, v243
    v_and_b32 v99, 0xffff0000, v243
    v_lshlrev_b32 v100, 16, v244
    v_and_b32 v101, 0xffff0000, v244
    v_lshlrev_b32 v102, 16, v245
    v_and_b32 v103, 0xffff0000, v245
    v_lshlrev_b32 v104, 16, v246
    v_and_b32 v105, 0xffff0000, v246
    v_lshlrev_b32 v106, 16, v247
    v_and_b32 v107, 0xffff0000, v247
    v_lshlrev_b32 v108, 16, v248
    v_and_b32 v109, 0xffff0000, v248
    v_lshlrev_b32 v110, 16, v249
    v_and_b32 v111, 0xffff0000, v249
    v_lshlrev_b32 v112, 16, v250
    v_and_b32 v113, 0xffff0000, v250
    v_lshlrev_b32 v114, 16, v251
    v_and_b32 v115, 0xffff0000, v251
    ds_write_b128 v3, v[20:23] offset:0
    ds_write_b128 v3, v[36:39] offset:1024
    ds_write_b128 v3, v[52:55] offset:2048
    ds_write_b128 v3, v[68:71] offset:3072
    ds_write_b128 v3, v[84:87] offset:4096
    ds_write_b128 v3, v[24:27] offset:51200
    ds_write_b128 v3, v[40:43] offset:52224
    ds_write_b128 v3, v[56:59] offset:53248
    ds_write_b128 v3, v[72:75] offset:54272
    ds_write_b128 v3, v[88:91] offset:55296
    ds_write_b128 v3, v[28:31] offset:25600
    ds_write_b128 v3, v[44:47] offset:26624
    ds_write_b128 v3, v[60:63] offset:27648
    ds_write_b128 v3, v[76:79] offset:28672
    ds_write_b128 v3, v[92:95] offset:29696
    s_mov_b64 exec, 1
    v_mov_b32 v8, 6
    ds_write_b32 v7, v8
    s_mov_b64 exec, -1
    s_sub_u32 s30, s3, 1
    s_and_b32 s30, s30, 3
    s_mul_i32 s30, s30, 6272
    s_add_u32 s30, s30, 84736
    v_add_u32 v117, s30, v2
    s_sub_u32 s30, s3, 2
    s_and_b32 s30, s30, 3
    s_mul_i32 s30, s30, 6272
    s_add_u32 s30, s30, 135936
    v_add_u32 v118, s30, v2
    s_sub_u32 s30, s3, 3
    s_and_b32 s30, s30, 3
    s_mul_i32 s30, s30, 6272
    s_add_u32 s30, s30, 110336
    v_add_u32 v119, s30, v2
    v_pk_add_f32 v[96:97], v[96:97], v[16:17]
    v_pk_add_f32 v[98:99], v[98:99], v[18:19]
    v_pk_add_f32 v[100:101], v[100:101], v[32:33]
    v_pk_add_f32 v[102:103], v[102:103], v[34:35]
    v_pk_add_f32 v[104:105], v[104:105], v[48:49]
    v_pk_add_f32 v[106:107], v[106:107], v[50:51]
    v_pk_add_f32 v[108:109], v[108:109], v[64:65]
    v_pk_add_f32 v[110:111], v[110:111], v[66:67]
    v_pk_add_f32 v[112:113], v[112:113], v[80:81]
    v_pk_add_f32 v[114:115], v[114:115], v[82:83]
    ds_read_b32 v8, v6
    s_waitcnt lgkmcnt(0)
    v_cmp_gt_u32 vcc, 6, v8
    s_cmp_eq_u64 vcc, 0
    s_cbranch_scc0 L_psl_55
L_pok_53:
    ds_read_b128 v[36:39], v117 offset:0
    ds_read_b128 v[40:43], v117 offset:1024
    ds_read_b128 v[44:47], v117 offset:2048
    ds_read_b128 v[48:51], v117 offset:3072
    ds_read_b128 v[52:55], v117 offset:4096
    ds_read_b128 v[56:59], v118 offset:0
    ds_read_b128 v[60:63], v118 offset:1024
    ds_read_b128 v[64:67], v118 offset:2048
    ds_read_b128 v[68:71], v118 offset:3072
    ds_read_b128 v[72:75], v118 offset:4096
    ds_read_b128 v[76:79], v119 offset:0
    ds_read_b128 v[80:83], v119 offset:1024
    ds_read_b128 v[84:87], v119 offset:2048
    ds_read_b128 v[88:91], v119 offset:3072
    ds_read_b128 v[92:95], v119 offset:4096
    s_waitcnt lgkmcnt(10)
    v_pk_add_f32 v[96:97], v[96:97], v[36:37]
    v_pk_add_f32 v[98:99], v[98:99], v[38:39]
    v_pk_add_f32 v[100:101], v[100:101], v[40:41]
    v_pk_add_f32 v[102:103], v[102:103], v[42:43]
    v_pk_add_f32 v[104:105], v[104:105], v[44:45]
    v_pk_add_f32 v[106:107], v[106:107], v[46:47]
    v_pk_add_f32 v[108:109], v[108:109], v[48:49]
    v_pk_add_f32 v[110:111], v[110:111], v[50:51]
    v_pk_add_f32 v[112:113], v[112:113], v[52:53]
    v_pk_add_f32 v[114:115], v[114:115], v[54:55]
    s_waitcnt lgkmcnt(5)
    v_pk_add_f32 v[96:97], v[96:97], v[56:57]
    v_pk_add_f32 v[98:99], v[98:99], v[58:59]
    v_pk_add_f32 v[100:101], v[100:101], v[60:61]
    v_pk_add_f32 v[102:103], v[102:103], v[62:63]
    v_pk_add_f32 v[104:105], v[104:105], v[64:65]
    v_pk_add_f32 v[106:107], v[106:107], v[66:67]
    v_pk_add_f32 v[108:109], v[108:109], v[68:69]
    v_pk_add_f32 v[110:111], v[110:111], v[70:71]
    v_pk_add_f32 v[112:113], v[112:113], v[72:73]
    v_pk_add_f32 v[114:115], v[114:115], v[74:75]
    s_waitcnt lgkmcnt(0)
    v_pk_add_f32 v[96:97], v[96:97], v[76:77]
    v_pk_add_f32 v[98:99], v[98:99], v[78:79]
    v_pk_add_f32 v[100:101], v[100:101], v[80:81]
    v_pk_add_f32 v[102:103], v[102:103], v[82:83]
    v_pk_add_f32 v[104:105], v[104:105], v[84:85]
    v_pk_add_f32 v[106:107], v[106:107], v[86:87]
    v_pk_add_f32 v[108:109], v[108:109], v[88:89]
    v_pk_add_f32 v[110:111], v[110:111], v[90:91]
    v_pk_add_f32 v[112:113], v[112:113], v[92:93]
    v_pk_add_f32 v[114:115], v[114:115], v[94:95]
    v_cvt_pk_bf16_f32 v120, v96, v97
    v_cvt_pk_bf16_f32 v121, v98, v99
    v_cvt_pk_bf16_f32 v122, v100, v101
    v_cvt_pk_bf16_f32 v123, v102, v103
    v_cvt_pk_bf16_f32 v124, v104, v105
    v_cvt_pk_bf16_f32 v125, v106, v107
    v_cvt_pk_bf16_f32 v126, v108, v109
    v_cvt_pk_bf16_f32 v127, v110, v111
    v_cvt_pk_bf16_f32 v128, v112, v113
    v_cvt_pk_bf16_f32 v129, v114, v115
    buffer_store_dwordx4 v[120:123], v254, s[16:19], s43 offen
    buffer_store_dwordx4 v[124:127], v254, s[16:19], s43 offen offset:16
    buffer_store_dwordx2 v[128:129], v254, s[16:19], s43 offen offset:32
    s_endpgm
L_psl_3:
    s_mov_b32 s63, 262144
L_plp_2:
    s_sleep 1
    ds_read_b32 v8, v6
    s_waitcnt lgkmcnt(0)
    s_sub_u32 s63, s63, 1
    s_cbranch_scc1 L_pok_1
    v_cmp_gt_u32 vcc, 1, v8
    s_cmp_eq_u64 vcc, 0
    s_cbranch_scc0 L_plp_2
    s_branch L_pok_1
L_psl_6:
    s_mov_b32 s63, 262144
L_plp_5:
    s_sleep 1
    ds_read_b32 v8, v6
    s_waitcnt lgkmcnt(0)
    s_sub_u32 s63, s63, 1
    s_cbranch_scc1 L_pok_4
    v_cmp_gt_u32 vcc, 2, v8
    s_cmp_eq_u64 vcc, 0
    s_cbranch_scc0 L_plp_5
    s_branch L_pok_4
L_psl_11:
    s_mov_b32 s63, 262144
L_plp_10:
    s_sleep 1
    ds_read_b32 v8, v4
    s_waitcnt lgkmcnt(0)
    s_sub_u32 s63, s63, 1
    s_cbranch_scc1 L_pok_9
    v_cmp_gt_u32 vcc, 4, v8
    s_cmp_eq_u64 vcc, 0
    s_cbranch_scc0 L_plp_10
    s_branch L_pok_9
L_psl_14:
    s_mov_b32 s63, 262144
L_plp_13:
    s_sleep 1
    ds_read_b32 v8, v11
    s_waitcnt lgkmcnt(0)
    s_sub_u32 s63, s63, 1
    s_cbranch_scc1 L_pok_12
    v_cmp_gt_u32 vcc, 8, v8
    s_cmp_eq_u64 vcc, 0
    s_cbranch_scc0 L_plp_13
    s_branch L_pok_12
L_psl_17:
    s_mov_b32 s63, 262144
L_plp_16:
    s_sleep 1
    ds_read_b32 v8, v11
    s_waitcnt lgkmcnt(0)
    s_sub_u32 s63, s63, 1
    s_cbranch_scc1 L_pok_15
    v_cmp_gt_u32 vcc, 10, v8
    s_cmp_eq_u64 vcc, 0
    s_cbranch_scc0 L_plp_16
    s_branch L_pok_15
L_psl_20:
    s_mov_b32 s63, 262144
L_plp_19:
    s_sleep 1
    ds_read_b32 v8, v11
    s_waitcnt lgkmcnt(0)
    s_sub_u32 s63, s63, 1
    s_cbranch_scc1 L_pok_18
    v_cmp_gt_u32 vcc, 12, v8
    s_cmp_eq_u64 vcc, 0
    s_cbranch_scc0 L_plp_19
    s_branch L_pok_18
L_rt_24:
    s_sub_u32 s63, s63, 1
    s_cbranch_scc1 L_go_25
    s_sleep 2
    buffer_load_dwordx4 v[136:139], v2, s[12:15], s36 offen offset:0 sc1
    buffer_load_dwordx4 v[140:143], v2, s[12:15], s36 offen offset:1024 sc1
    buffer_load_dwordx4 v[144:147], v2, s[12:15], s36 offen offset:2048 sc1
    buffer_load_dwordx4 v[148:151], v2, s[12:15], s36 offen offset:3072 sc1
    buffer_load_dwordx4 v[152:155], v2, s[12:15], s30 offen offset:0 sc1
    buffer_load_dwordx4 v[156:159], v2, s[12:15], s30 offen offset:1024 sc1
    buffer_load_dwordx4 v[160:163], v2, s[12:15], s30 offen offset:2048 sc1
    buffer_load_dwordx4 v[164:167], v2, s[12:15], s30 offen offset:3072 sc1
    buffer_load_dwordx4 v[168:171], v2, s[12:15], s31 offen offset:0 sc1
    buffer_load_dwordx4 v[172:175], v2, s[12:15], s31 offen offset:1024 sc1
    s_waitcnt vmcnt(9)
    s_branch L_ck_23
L_rt_27:
    s_sub_u32 s63, s63, 1
    s_cbranch_scc1 L_go_28
    s_sleep 2
    buffer_load_dwordx4 v[140:143], v2, s[12:15], s36 offen offset:1024 sc1
    buffer_load_dwordx4 v[144:147], v2, s[12:15], s36 offen offset:2048 sc1
    buffer_load_dwordx4 v[148:151], v2, s[12:15], s36 offen offset:3072 sc1
    buffer_load_dwordx4 v[152:155], v2, s[12:15], s30 offen offset:0 sc1
    buffer_load_dwordx4 v[156:159], v2, s[12:15], s30 offen offset:1024 sc1
    buffer_load_dwordx4 v[160:163], v2, s[12:15], s30 offen offset:2048 sc1
    buffer_load_dwordx4 v[164:167], v2, s[12:15], s30 offen offset:3072 sc1
    buffer_load_dwordx4 v[168:171], v2, s[12:15], s31 offen offset:0 sc1
    buffer_load_dwordx4 v[172:175], v2, s[12:15], s31 offen offset:1024 sc1
    s_waitcnt vmcnt(8)
    s_branch L_ck_26
L_rt_30:
    s_sub_u32 s63, s63, 1
    s_cbranch_scc1 L_go_31
    s_sleep 2
    buffer_load_dwordx4 v[144:147], v2, s[12:15], s36 offen offset:2048 sc1
    buffer_load_dwordx4 v[148:151], v2, s[12:15], s36 offen offset:3072 sc1
    buffer_load_dwordx4 v[152:155], v2, s[12:15], s30 offen offset:0 sc1
    buffer_load_dwordx4 v[156:159], v2, s[12:15], s30 offen offset:1024 sc1
    buffer_load_dwordx4 v[160:163], v2, s[12:15], s30 offen offset:2048 sc1
    buffer_load_dwordx4 v[164:167], v2, s[12:15], s30 offen offset:3072 sc1
    buffer_load_dwordx4 v[168:171], v2, s[12:15], s31 offen offset:0 sc1
    buffer_load_dwordx4 v[172:175], v2, s[12:15], s31 offen offset:1024 sc1
    s_waitcnt vmcnt(7)
    s_branch L_ck_29
L_rt_33:
    s_sub_u32 s63, s63, 1
    s_cbranch_scc1 L_go_34
    s_sleep 2
    buffer_load_dwordx4 v[148:151], v2, s[12:15], s36 offen offset:3072 sc1
    buffer_load_dwordx4 v[152:155], v2, s[12:15], s30 offen offset:0 sc1
    buffer_load_dwordx4 v[156:159], v2, s[12:15], s30 offen offset:1024 sc1
    buffer_load_dwordx4 v[160:163], v2, s[12:15], s30 offen offset:2048 sc1
    buffer_load_dwordx4 v[164:167], v2, s[12:15], s30 offen offset:3072 sc1
    buffer_load_dwordx4 v[168:171], v2, s[12:15], s31 offen offset:0 sc1
    buffer_load_dwordx4 v[172:175], v2, s[12:15], s31 offen offset:1024 sc1
    s_waitcnt vmcnt(6)
    s_branch L_ck_32
L_rt_36:
    s_sub_u32 s63, s63, 1
    s_cbranch_scc1 L_go_37
    s_sleep 2
    buffer_load_dwordx4 v[152:155], v2, s[12:15], s30 offen offset:0 sc1
    buffer_load_dwordx4 v[156:159], v2, s[12:15], s30 offen offset:1024 sc1
    buffer_load_dwordx4 v[160:163], v2, s[12:15], s30 offen offset:2048 sc1
    buffer_load_dwordx4 v[164:167], v2, s[12:15], s30 offen offset:3072 sc1
    buffer_load_dwordx4 v[168:171], v2, s[12:15], s31 offen offset:0 sc1
    buffer_load_dwordx4 v[172:175], v2, s[12:15], s31 offen offset:1024 sc1
    s_waitcnt vmcnt(5)
    s_branch L_ck_35
L_rt_39:
    s_sub_u32 s63, s63, 1
    s_cbranch_scc1 L_go_40
    s_sleep 2
    buffer_load_dwordx4 v[156:159], v2, s[12:15], s30 offen offset:1024 sc1
    buffer_load_dwordx4 v[160:163], v2, s[12:15], s30 offen offset:2048 sc1
    buffer_load_dwordx4 v[164:167], v2, s[12:15], s30 offen offset:3072 sc1
    buffer_load_dwordx4 v[168:171], v2, s[12:15], s31 offen offset:0 sc1
    buffer_load_dwordx4 v[172:175], v2, s[12:15], s31 offen offset:1024 sc1
    s_waitcnt vmcnt(4)
    s_branch L_ck_38
L_rt_42:
    s_sub_u32 s63, s63, 1
    s_cbranch_scc1 L_go_43
    s_sleep 2
    buffer_load_dwordx4 v[160:163], v2, s[12:15], s30 offen offset:2048 sc1
    buffer_load_dwordx4 v[164:167], v2, s[12:15], s30 offen offset:3072 sc1
    buffer_load_dwordx4 v[168:171], v2, s[12:15], s31 offen offset:0 sc1
    buffer_load_dwordx4 v[172:175], v2, s[12:15], s31 offen offset:1024 sc1
    s_waitcnt vmcnt(3)
    s_branch L_ck_41
L_rt_45:
    s_sub_u32 s63, s63, 1
    s_cbranch_scc1 L_go_46
    s_sleep 2
    buffer_load_dwordx4 v[164:167], v2, s[12:15], s30 offen offset:3072 sc1
    buffer_load_dwordx4 v[168:171], v2, s[12:15], s31 offen offset:0 sc1
    buffer_load_dwordx4 v[172:175], v2, s[12:15], s31 offen offset:1024 sc1
    s_waitcnt vmcnt(2)
    s_branch L_ck_44
L_rt_48:
    s_sub_u32 s63, s63, 1
    s_cbranch_scc1 L_go_49
    s_sleep 2
    buffer_load_dwordx4 v[168:171], v2, s[12:15], s31 offen offset:0 sc1
    buffer_load_dwordx4 v[172:175], v2, s[12:15], s31 offen offset:1024 sc1
    s_waitcnt vmcnt(1)
    s_branch L_ck_47
L_rt_51:
    s_sub_u32 s63, s63, 1
    s_cbranch_scc1 L_go_52
    s_sleep 2
    buffer_load_dwordx4 v[172:175], v2, s[12:15], s31 offen offset:1024 sc1
    s_waitcnt vmcnt(0)
    s_branch L_ck_50
L_psl_55:
    s_mov_b32 s63, 262144
L_plp_54:
    s_sleep 1
    ds_read_b32 v8, v6
    s_waitcnt lgkmcnt(0)
    s_sub_u32 s63, s63, 1
    s_cbranch_scc1 L_pok_53
    v_cmp_gt_u32 vcc, 6, v8
    s_cmp_eq_u64 vcc, 0
    s_cbranch_scc0 L_plp_54
    s_branch L_pok_53
L_a_role:
    s_mov_b32 s12, s66
    s_mov_b32 s13, s67
    s_mov_b32 s14, 819200
    s_mov_b32 s15, 0x00020000
    v_add_u32 v3, 0, v1
    v_mul_u32_u24 v4, 205, v3
    v_lshrrev_b32 v4, 11, v4
    v_mul_u32_u24 v216, 10, v4
    v_sub_u32 v3, v3, v216
    v_lshlrev_b32 v3, 4, v3
    v_mul_u32_u24 v216, 1280, v4
    v_add_u32 v216, v216, v3
    v_add_u32 v3, 64, v1
    v_mul_u32_u24 v4, 205, v3
    v_lshrrev_b32 v4, 11, v4
    v_mul_u32_u24 v217, 10, v4
    v_sub_u32 v3, v3, v217
    v_lshlrev_b32 v3, 4, v3
    v_subrev_u32 v3, 1024, v3
    v_mul_u32_u24 v217, 1280, v4
    v_add_u32 v217, v217, v3
    v_add_u32 v3, 128, v1
    v_mul_u32_u24 v4, 205, v3
    v_lshrrev_b32 v4, 11, v4
    v_mul_u32_u24 v218, 10, v4
    v_sub_u32 v3, v3, v218
    v_lshlrev_b32 v3, 4, v3
    v_subrev_u32 v3, 2048, v3
    v_mul_u32_u24 v218, 1280, v4
    v_add_u32 v218, v218, v3
    v_add_u32 v3, 192, v1
    v_mul_u32_u24 v4, 205, v3
    v_lshrrev_b32 v4, 11, v4
    v_mul_u32_u24 v219, 10, v4
    v_sub_u32 v3, v3, v219
    v_lshlrev_b32 v3, 4, v3
    v_subrev_u32 v3, 3072, v3
    v_mul_u32_u24 v219, 1280, v4
    v_add_u32 v219, v219, v3
    v_add_u32 v3, 256, v1
    v_mul_u32_u24 v4, 205, v3
    v_lshrrev_b32 v4, 11, v4
    v_mul_u32_u24 v220, 10, v4
    v_sub_u32 v3, v3, v220
    v_lshlrev_b32 v3, 4, v3
    v_mul_u32_u24 v220, 1280, v4
    v_add_u32 v220, v220, v3
    s_lshl_b32 s24, s5, 2
    s_add_u32 s24, s24, s3
    s_mul_i32 s25, s5, 160
    s_mul_i32 s26, s3, 40960
    s_add_u32 s25, s25, s26
    s_mul_i32 s26, s3, 5120
    s_add_u32 s26, s26, 84736
    s_mov_b32 s16, s76
    s_mov_b32 s17, s77
    s_mov_b32 s18, 1966080
    s_mov_b32 s19, 0x00020000
    s_mov_b32 s20, s78
    s_mov_b32 s21, s79
    s_mov_b32 s22, 1966080
    s_mov_b32 s23, 0x00020000
    v_mul_u32_u24 v3, 256, v1
    v_lshrrev_b32 v3, 9, v3
    v_mul_u32_u24 v226, 2, v3
    v_sub_u32 v226, v1, v226
    v_lshlrev_b32 v226, 7, v226
    v_min_u32 v226, 156, v226
    v_min_u32 v3, 9, v3
    v_mul_u32_u24 v3, 1280, v3
    v_add_u32 v226, v226, v3
    v_mul_u32_u24 v3, 171, v1
    v_lshrrev_b32 v3, 9, v3
    v_mul_u32_u24 v227, 3, v3
    v_sub_u32 v227, v1, v227
    v_lshlrev_b32 v227, 7, v227
    v_min_u32 v227, 380, v227
    v_min_u32 v3, 0, v3
    v_mul_u32_u24 v3, 3072, v3
    v_add_u32 v227, v227, v3
    s_and_b32 s32, s4, 15
    s_lshl_b32 s32, s32, 2
    s_add_u32 s32, s32, s3
    s_mul_i32 s33, s32, 0
    s_mul_i32 s32, s32, 12800
    s_mul_i32 s34, s5, 160
    s_add_u32 s32, s32, s34
    s_mul_i32 s34, s5, 384
    s_add_u32 s33, s33, s34
    v_and_b32 v3, 7, v1
    v_lshlrev_b32 v225, 2, v3
    v_and_b32 v6, 12, v225
    v_add_u32 v224, 16, v6
    v_lshrrev_b32 v4, 5, v1
    v_bfe_u32 v7, v1, 2, 2
    v_lshl_add_u32 v7, v4, 3, v7
    v_mul_u32_u24 v7, 160, v7
    v_mul_u32_u24 v221, 528, v4
    v_and_b32 v4, 1, v1
    v_lshlrev_b32 v4, 4, v4
    v_bfe_u32 v3, v1, 1, 1
    v_lshl_add_u32 v4, v3, 3, v4
    v_and_b32 v3, 16, v1
    v_cmp_eq_u32 vcc, 0, v3
    v_mov_b32 v3, 32
    s_mul_i32 s30, s3, 40
    s_add_u32 s30, s30, 84736
    v_cndmask_b32 v4, v3, v4, vcc
    v_add3_u32 v7, v7, v4, s30
    v_and_b32 v3, 31, v1
    v_lshl_add_u32 v221, v3, 4, v221
    v_add_u32 v221, 256, v221
    v_add_u32 v222, 42240, v221
    s_lshl_b32 s30, s3, 2
    v_mov_b32 v223, s30
    s_add_u32 s42, s3, 4
    s_cmp_ge_u32 s42, s5
    s_addc_u32 s42, s42, 0
    s_lshl_b32 s43, s4, 3
    s_add_u32 s43, s43, s42
    s_mul_i32 s43, s43, 10240
    v_lshrrev_b32 v4, 3, v1
    v_mul_u32_u24 v228, 1280, v4
    v_and_b32 v3, 7, v1
    v_lshl_add_u32 v228, v3, 4, v228
    v_mul_u32_u24 v229, 528, v3
    v_lshl_add_u32 v229, v4, 4, v229
    s_and_b32 s63, s42, 3
    s_lshl_b32 s63, s63, 7
    s_lshr_b32 s42, s42, 2
    s_mul_i32 s42, s42, 42240
    s_add_u32 s42, s42, s63
    s_add_u32 s42, s42, 256
    v_add_u32 v229, s42, v229
    s_waitcnt vmcnt(9)
    v_lshlrev_b32 v96, 16, v16
    v_and_b32 v97, 0xffff0000, v16
    v_lshlrev_b32 v98, 16, v17
    v_and_b32 v99, 0xffff0000, v17
    v_lshlrev_b32 v100, 16, v18
    v_and_b32 v101, 0xffff0000, v18
    v_lshlrev_b32 v102, 16, v19
    v_and_b32 v103, 0xffff0000, v19
    v_pk_mul_f32 v[14:15], v[96:97], v[96:97]
    v_pk_add_f32 v[12:13], v[96:97], v[98:99]
    v_pk_fma_f32 v[14:15], v[98:99], v[98:99], v[14:15]
    v_pk_add_f32 v[12:13], v[12:13], v[100:101]
    v_pk_fma_f32 v[14:15], v[100:101], v[100:101], v[14:15]
    v_pk_add_f32 v[12:13], v[12:13], v[102:103]
    v_pk_fma_f32 v[14:15], v[102:103], v[102:103], v[14:15]
    s_waitcnt vmcnt(8)
    v_lshlrev_b32 v104, 16, v20
    v_and_b32 v105, 0xffff0000, v20
    v_lshlrev_b32 v106, 16, v21
    v_and_b32 v107, 0xffff0000, v21
    v_lshlrev_b32 v108, 16, v22
    v_and_b32 v109, 0xffff0000, v22
    v_lshlrev_b32 v110, 16, v23
    v_and_b32 v111, 0xffff0000, v23
    v_pk_add_f32 v[12:13], v[12:13], v[104:105]
    v_pk_fma_f32 v[14:15], v[104:105], v[104:105], v[14:15]
    v_pk_add_f32 v[12:13], v[12:13], v[106:107]
    v_pk_fma_f32 v[14:15], v[106:107], v[106:107], v[14:15]
    v_pk_add_f32 v[12:13], v[12:13], v[108:109]
    v_pk_fma_f32 v[14:15], v[108:109], v[108:109], v[14:15]
    v_pk_add_f32 v[12:13], v[12:13], v[110:111]
    v_pk_fma_f32 v[14:15], v[110:111], v[110:111], v[14:15]
    s_waitcnt vmcnt(7)
    v_lshlrev_b32 v112, 16, v24
    v_and_b32 v113, 0xffff0000, v24
    v_lshlrev_b32 v114, 16, v25
    v_and_b32 v115, 0xffff0000, v25
    v_lshlrev_b32 v116, 16, v26
    v_and_b32 v117, 0xffff0000, v26
    v_lshlrev_b32 v118, 16, v27
    v_and_b32 v119, 0xffff0000, v27
    v_pk_add_f32 v[12:13], v[12:13], v[112:113]
    v_pk_fma_f32 v[14:15], v[112:113], v[112:113], v[14:15]
    v_pk_add_f32 v[12:13], v[12:13], v[114:115]
    v_pk_fma_f32 v[14:15], v[114:115], v[114:115], v[14:15]
    v_pk_add_f32 v[12:13], v[12:13], v[116:117]
    v_pk_fma_f32 v[14:15], v[116:117], v[116:117], v[14:15]
    v_pk_add_f32 v[12:13], v[12:13], v[118:119]
    v_pk_fma_f32 v[14:15], v[118:119], v[118:119], v[14:15]
    s_waitcnt vmcnt(6)
    v_lshlrev_b32 v120, 16, v28
    v_and_b32 v121, 0xffff0000, v28
    v_lshlrev_b32 v122, 16, v29
    v_and_b32 v123, 0xffff0000, v29
    v_lshlrev_b32 v124, 16, v30
    v_and_b32 v125, 0xffff0000, v30
    v_lshlrev_b32 v126, 16, v31
    v_and_b32 v127, 0xffff0000, v31
    v_pk_add_f32 v[12:13], v[12:13], v[120:121]
    v_pk_fma_f32 v[14:15], v[120:121], v[120:121], v[14:15]
    v_pk_add_f32 v[12:13], v[12:13], v[122:123]
    v_pk_fma_f32 v[14:15], v[122:123], v[122:123], v[14:15]
    v_pk_add_f32 v[12:13], v[12:13], v[124:125]
    v_pk_fma_f32 v[14:15], v[124:125], v[124:125], v[14:15]
    v_pk_add_f32 v[12:13], v[12:13], v[126:127]
    v_pk_fma_f32 v[14:15], v[126:127], v[126:127], v[14:15]
    s_waitcnt vmcnt(5)
    v_lshlrev_b32 v128, 16, v32
    v_and_b32 v129, 0xffff0000, v32
    v_lshlrev_b32 v130, 16, v33
    v_and_b32 v131, 0xffff0000, v33
    v_lshlrev_b32 v132, 16, v34
    v_and_b32 v133, 0xffff0000, v34
    v_lshlrev_b32 v134, 16, v35
    v_and_b32 v135, 0xffff0000, v35
    v_pk_add_f32 v[12:13], v[12:13], v[128:129]
    v_pk_fma_f32 v[14:15], v[128:129], v[128:129], v[14:15]
    v_pk_add_f32 v[12:13], v[12:13], v[130:131]
    v_pk_fma_f32 v[14:15], v[130:131], v[130:131], v[14:15]
    v_pk_add_f32 v[12:13], v[12:13], v[132:133]
    v_pk_fma_f32 v[14:15], v[132:133], v[132:133], v[14:15]
    v_pk_add_f32 v[12:13], v[12:13], v[134:135]
    v_pk_fma_f32 v[14:15], v[134:135], v[134:135], v[14:15]
    s_waitcnt vmcnt(4)
    v_lshlrev_b32 v136, 16, v36
    v_and_b32 v137, 0xffff0000, v36
    v_lshlrev_b32 v138, 16, v37
    v_and_b32 v139, 0xffff0000, v37
    v_lshlrev_b32 v140, 16, v38
    v_and_b32 v141, 0xffff0000, v38
    v_lshlrev_b32 v142, 16, v39
    v_and_b32 v143, 0xffff0000, v39
    v_pk_add_f32 v[12:13], v[12:13], v[136:137]
    v_pk_fma_f32 v[14:15], v[136:137], v[136:137], v[14:15]
    v_pk_add_f32 v[12:13], v[12:13], v[138:139]
    v_pk_fma_f32 v[14:15], v[138:139], v[138:139], v[14:15]
    v_pk_add_f32 v[12:13], v[12:13], v[140:141]
    v_pk_fma_f32 v[14:15], v[140:141], v[140:141], v[14:15]
    v_pk_add_f32 v[12:13], v[12:13], v[142:143]
    v_pk_fma_f32 v[14:15], v[142:143], v[142:143], v[14:15]
    s_waitcnt vmcnt(3)
    v_lshlrev_b32 v144, 16, v40
    v_and_b32 v145, 0xffff0000, v40
    v_lshlrev_b32 v146, 16, v41
    v_and_b32 v147, 0xffff0000, v41
    v_lshlrev_b32 v148, 16, v42
    v_and_b32 v149, 0xffff0000, v42
    v_lshlrev_b32 v150, 16, v43
    v_and_b32 v151, 0xffff0000, v43
    v_pk_add_f32 v[12:13], v[12:13], v[144:145]
    v_pk_fma_f32 v[14:15], v[144:145], v[144:145], v[14:15]
    v_pk_add_f32 v[12:13], v[12:13], v[146:147]
    v_pk_fma_f32 v[14:15], v[146:147], v[146:147], v[14:15]
    v_pk_add_f32 v[12:13], v[12:13], v[148:149]
    v_pk_fma_f32 v[14:15], v[148:149], v[148:149], v[14:15]
    v_pk_add_f32 v[12:13], v[12:13], v[150:151]
    v_pk_fma_f32 v[14:15], v[150:151], v[150:151], v[14:15]
    s_waitcnt vmcnt(2)
    v_lshlrev_b32 v152, 16, v44
    v_and_b32 v153, 0xffff0000, v44
    v_lshlrev_b32 v154, 16, v45
    v_and_b32 v155, 0xffff0000, v45
    v_lshlrev_b32 v156, 16, v46
    v_and_b32 v157, 0xffff0000, v46
    v_lshlrev_b32 v158, 16, v47
    v_and_b32 v159, 0xffff0000, v47
    v_pk_add_f32 v[12:13], v[12:13], v[152:153]
    v_pk_fma_f32 v[14:15], v[152:153], v[152:153], v[14:15]
    v_pk_add_f32 v[12:13], v[12:13], v[154:155]
    v_pk_fma_f32 v[14:15], v[154:155], v[154:155], v[14:15]
    v_pk_add_f32 v[12:13], v[12:13], v[156:157]
    v_pk_fma_f32 v[14:15], v[156:157], v[156:157], v[14:15]
    v_pk_add_f32 v[12:13], v[12:13], v[158:159]
    v_pk_fma_f32 v[14:15], v[158:159], v[158:159], v[14:15]
    s_waitcnt vmcnt(1)
    v_lshlrev_b32 v160, 16, v48
    v_and_b32 v161, 0xffff0000, v48
    v_lshlrev_b32 v162, 16, v49
    v_and_b32 v163, 0xffff0000, v49
    v_lshlrev_b32 v164, 16, v50
    v_and_b32 v165, 0xffff0000, v50
    v_lshlrev_b32 v166, 16, v51
    v_and_b32 v167, 0xffff0000, v51
    v_pk_add_f32 v[12:13], v[12:13], v[160:161]
    v_pk_fma_f32 v[14:15], v[160:161], v[160:161], v[14:15]
    v_pk_add_f32 v[12:13], v[12:13], v[162:163]
    v_pk_fma_f32 v[14:15], v[162:163], v[162:163], v[14:15]
    v_pk_add_f32 v[12:13], v[12:13], v[164:165]
    v_pk_fma_f32 v[14:15], v[164:165], v[164:165], v[14:15]
    v_pk_add_f32 v[12:13], v[12:13], v[166:167]
    v_pk_fma_f32 v[14:15], v[166:167], v[166:167], v[14:15]
    s_waitcnt vmcnt(0)
    v_lshlrev_b32 v168, 16, v52
    v_and_b32 v169, 0xffff0000, v52
    v_lshlrev_b32 v170, 16, v53
    v_and_b32 v171, 0xffff0000, v53
    s_cmp_eq_u32 s3, 3
    s_cbranch_scc1 L_x1_56
    buffer_load_dwordx4 v[56:59], v228, s[8:11], s43 offen offset:0
L_x1_56:
    v_lshlrev_b32 v172, 16, v54
    v_and_b32 v173, 0xffff0000, v54
    v_lshlrev_b32 v174, 16, v55
    v_and_b32 v175, 0xffff0000, v55
    s_cmp_eq_u32 s3, 3
    s_cbranch_scc1 L_x1_57
    buffer_load_dwordx4 v[60:63], v228, s[8:11], s43 offen offset:128
L_x1_57:
    v_pk_add_f32 v[12:13], v[12:13], v[168:169]
    v_pk_fma_f32 v[14:15], v[168:169], v[168:169], v[14:15]
    v_pk_add_f32 v[12:13], v[12:13], v[170:171]
    v_pk_fma_f32 v[14:15], v[170:171], v[170:171], v[14:15]
    s_cmp_eq_u32 s3, 3
    s_cbranch_scc1 L_x1_58
    buffer_load_dwordx4 v[64:67], v228, s[8:11], s43 offen offset:256
L_x1_58:
    v_pk_add_f32 v[12:13], v[12:13], v[172:173]
    v_pk_fma_f32 v[14:15], v[172:173], v[172:173], v[14:15]
    v_pk_add_f32 v[12:13], v[12:13], v[174:175]
    v_pk_fma_f32 v[14:15], v[174:175], v[174:175], v[14:15]
    s_cmp_eq_u32 s3, 3
    s_cbranch_scc1 L_x1_59
    buffer_load_dwordx4 v[68:71], v228, s[8:11], s43 offen offset:384
L_x1_59:
    v_add_f32 v12, v12, v13
    v_add_f32 v14, v14, v15
    s_nop 0
    v_add_f32_dpp v12, v12, v12 quad_perm:[1,0,3,2] row_mask:0xf bank_mask:0xf
    v_add_f32_dpp v14, v14, v14 quad_perm:[1,0,3,2] row_mask:0xf bank_mask:0xf
    s_cmp_eq_u32 s3, 3
    s_cbranch_scc1 L_x1_60
    buffer_load_dwordx4 v[72:75], v228, s[8:11], s43 offen offset:512
L_x1_60:
    s_nop 0
    v_add_f32_dpp v12, v12, v12 quad_perm:[2,3,0,1] row_mask:0xf bank_mask:0xf
    v_add_f32_dpp v14, v14, v14 quad_perm:[2,3,0,1] row_mask:0xf bank_mask:0xf
    s_nop 0
    v_add_f32_dpp v12, v12, v12 row_half_mirror row_mask:0xf bank_mask:0xf
    v_add_f32_dpp v14, v14, v14 row_half_mirror row_mask:0xf bank_mask:0xf
    s_cmp_eq_u32 s3, 3
    s_cbranch_scc1 L_x1_61
    buffer_load_dwordx4 v[76:79], v228, s[8:11], s43 offen offset:640
L_x1_61:
    s_nop 0
    v_mul_f32 v12, 0x3acccccd, v12
    v_mul_f32 v14, 0x3acccccd, v14
    v_fma_f32 v14, -v12, v12, v14
    v_max_f32 v14, 0, v14
    s_cmp_eq_u32 s3, 3
    s_cbranch_scc1 L_x1_62
    buffer_load_dwordx4 v[80:83], v228, s[8:11], s43 offen offset:768
L_x1_62:
    v_add_f32 v14, 0x3727c5ac, v14
    v_rsq_f32 v14, v14
    s_nop 0
    v_mul_f32 v12, v12, v14
    v_mov_b32 v15, v14
    s_cmp_eq_u32 s3, 3
    s_cbranch_scc1 L_x1_63
    buffer_load_dwordx4 v[84:87], v228, s[8:11], s43 offen offset:896
L_x1_63:
    v_sub_f32 v12, 0, v12
    v_mov_b32 v13, v12
    v_pk_fma_f32 v[96:97], v[96:97], v[14:15], v[12:13]
    v_pk_fma_f32 v[98:99], v[98:99], v[14:15], v[12:13]
    s_cmp_eq_u32 s3, 3
    s_cbranch_scc1 L_x1_64
    buffer_load_dwordx4 v[88:91], v228, s[8:11], s43 offen offset:1024
L_x1_64:
    v_pk_fma_f32 v[100:101], v[100:101], v[14:15], v[12:13]
    v_pk_fma_f32 v[102:103], v[102:103], v[14:15], v[12:13]
    v_cvt_pk_bf16_f32 v16, v96, v97
    v_cvt_pk_bf16_f32 v17, v98, v99
    s_cmp_eq_u32 s3, 3
    s_cbranch_scc1 L_x1_65
    buffer_load_dwordx4 v[92:95], v228, s[8:11], s43 offen offset:1152
L_x1_65:
    v_cvt_pk_bf16_f32 v18, v100, v101
    v_cvt_pk_bf16_f32 v19, v102, v103
    ds_write_b128 v11, v[16:19] offset:0
    v_pk_fma_f32 v[104:105], v[104:105], v[14:15], v[12:13]
    v_pk_fma_f32 v[106:107], v[106:107], v[14:15], v[12:13]
    buffer_load_dword v10, v226, s[12:15], s32 offen
    v_pk_fma_f32 v[108:109], v[108:109], v[14:15], v[12:13]
    v_pk_fma_f32 v[110:111], v[110:111], v[14:15], v[12:13]
    v_cvt_pk_bf16_f32 v20, v104, v105
    v_cvt_pk_bf16_f32 v21, v106, v107
    s_add_u32 m0, s26, 20480
    s_add_u32 s27, s25, 163840
    s_cmp_lg_u32 s3, 0
    s_cbranch_scc1 L_g4_66
    buffer_load_dwordx4 v216, s[12:15], s27 offen offset:0 lds
L_g4_66:
    v_cvt_pk_bf16_f32 v22, v108, v109
    v_cvt_pk_bf16_f32 v23, v110, v111
    ds_write_b128 v11, v[20:23] offset:4224
    v_pk_fma_f32 v[112:113], v[112:113], v[14:15], v[12:13]
    v_pk_fma_f32 v[114:115], v[114:115], v[14:15], v[12:13]
    s_add_u32 m0, s26, 20480
    s_add_u32 s27, s25, 163840
    s_cmp_lg_u32 s3, 0
    s_cbranch_scc1 L_g4_67
    buffer_load_dwordx4 v217, s[12:15], s27 offen offset:1024 lds
L_g4_67:
    v_pk_fma_f32 v[116:117], v[116:117], v[14:15], v[12:13]
    v_pk_fma_f32 v[118:119], v[118:119], v[14:15], v[12:13]
    v_cvt_pk_bf16_f32 v24, v112, v113
    v_cvt_pk_bf16_f32 v25, v114, v115
    s_add_u32 m0, s26, 20480
    s_add_u32 s27, s25, 163840
    s_cmp_lg_u32 s3, 0
    s_cbranch_scc1 L_g4_68
    buffer_load_dwordx4 v218, s[12:15], s27 offen offset:2048 lds
L_g4_68:
    v_cvt_pk_bf16_f32 v26, v116, v117
    v_cvt_pk_bf16_f32 v27, v118, v119
    ds_write_b128 v11, v[24:27] offset:8448
    v_pk_fma_f32 v[120:121], v[120:121], v[14:15], v[12:13]
    v_pk_fma_f32 v[122:123], v[122:123], v[14:15], v[12:13]
    s_add_u32 m0, s26, 20480
    s_add_u32 s27, s25, 163840
    s_cmp_lg_u32 s3, 0
    s_cbranch_scc1 L_g4_69
    buffer_load_dwordx4 v219, s[12:15], s27 offen offset:3072 lds
L_g4_69:
    v_pk_fma_f32 v[124:125], v[124:125], v[14:15], v[12:13]
    v_pk_fma_f32 v[126:127], v[126:127], v[14:15], v[12:13]
    v_cvt_pk_bf16_f32 v28, v120, v121
    v_cvt_pk_bf16_f32 v29, v122, v123
    s_add_u32 m0, s26, 24576
    s_add_u32 s27, s25, 163840
    s_cmp_lg_u32 s3, 0
    s_cbranch_scc1 L_g4_70
    buffer_load_dwordx4 v220, s[12:15], s27 offen lds
L_g4_70:
    v_cvt_pk_bf16_f32 v30, v124, v125
    v_cvt_pk_bf16_f32 v31, v126, v127
    ds_write_b128 v11, v[28:31] offset:12672
    v_pk_fma_f32 v[128:129], v[128:129], v[14:15], v[12:13]
    v_pk_fma_f32 v[130:131], v[130:131], v[14:15], v[12:13]
    s_add_u32 m0, s26, 0
    s_add_u32 s27, s25, 0
    buffer_load_dwordx4 v216, s[12:15], s27 offen offset:0 lds
    v_pk_fma_f32 v[132:133], v[132:133], v[14:15], v[12:13]
    v_pk_fma_f32 v[134:135], v[134:135], v[14:15], v[12:13]
    v_cvt_pk_bf16_f32 v32, v128, v129
    v_cvt_pk_bf16_f32 v33, v130, v131
    s_add_u32 m0, s26, 0
    s_add_u32 s27, s25, 0
    buffer_load_dwordx4 v217, s[12:15], s27 offen offset:1024 lds
    v_cvt_pk_bf16_f32 v34, v132, v133
    v_cvt_pk_bf16_f32 v35, v134, v135
    ds_write_b128 v11, v[32:35] offset:16896
    v_pk_fma_f32 v[136:137], v[136:137], v[14:15], v[12:13]
    v_pk_fma_f32 v[138:139], v[138:139], v[14:15], v[12:13]
    s_add_u32 m0, s26, 0
    s_add_u32 s27, s25, 0
    buffer_load_dwordx4 v218, s[12:15], s27 offen offset:2048 lds
    v_pk_fma_f32 v[140:141], v[140:141], v[14:15], v[12:13]
    v_pk_fma_f32 v[142:143], v[142:143], v[14:15], v[12:13]
    v_cvt_pk_bf16_f32 v36, v136, v137
    v_cvt_pk_bf16_f32 v37, v138, v139
    s_add_u32 m0, s26, 0
    s_add_u32 s27, s25, 0
    buffer_load_dwordx4 v219, s[12:15], s27 offen offset:3072 lds
    v_cvt_pk_bf16_f32 v38, v140, v141
    v_cvt_pk_bf16_f32 v39, v142, v143
    ds_write_b128 v11, v[36:39] offset:21120
    v_pk_fma_f32 v[144:145], v[144:145], v[14:15], v[12:13]
    v_pk_fma_f32 v[146:147], v[146:147], v[14:15], v[12:13]
    s_add_u32 m0, s26, 4096
    s_add_u32 s27, s25, 0
    buffer_load_dwordx4 v220, s[12:15], s27 offen lds
    v_pk_fma_f32 v[148:149], v[148:149], v[14:15], v[12:13]
    v_pk_fma_f32 v[150:151], v[150:151], v[14:15], v[12:13]
    v_cvt_pk_bf16_f32 v40, v144, v145
    v_cvt_pk_bf16_f32 v41, v146, v147
    v_cvt_pk_bf16_f32 v42, v148, v149
    v_cvt_pk_bf16_f32 v43, v150, v151
    ds_write_b128 v11, v[40:43] offset:25344
    v_pk_fma_f32 v[152:153], v[152:153], v[14:15], v[12:13]
    v_pk_fma_f32 v[154:155], v[154:155], v[14:15], v[12:13]
    v_pk_fma_f32 v[156:157], v[156:157], v[14:15], v[12:13]
    v_pk_fma_f32 v[158:159], v[158:159], v[14:15], v[12:13]
    v_cvt_pk_bf16_f32 v44, v152, v153
    v_cvt_pk_bf16_f32 v45, v154, v155
    v_cvt_pk_bf16_f32 v46, v156, v157
    v_cvt_pk_bf16_f32 v47, v158, v159
    ds_write_b128 v11, v[44:47] offset:29568
    v_pk_fma_f32 v[160:161], v[160:161], v[14:15], v[12:13]
    v_pk_fma_f32 v[162:163], v[162:163], v[14:15], v[12:13]
    v_pk_fma_f32 v[164:165], v[164:165], v[14:15], v[12:13]
    v_pk_fma_f32 v[166:167], v[166:167], v[14:15], v[12:13]
    v_cvt_pk_bf16_f32 v48, v160, v161
    v_cvt_pk_bf16_f32 v49, v162, v163
    v_cvt_pk_bf16_f32 v50, v164, v165
    v_cvt_pk_bf16_f32 v51, v166, v167
    ds_write_b128 v11, v[48:51] offset:33792
    v_pk_fma_f32 v[168:169], v[168:169], v[14:15], v[12:13]
    v_pk_fma_f32 v[170:171], v[170:171], v[14:15], v[12:13]
    v_pk_fma_f32 v[172:173], v[172:173], v[14:15], v[12:13]
    v_pk_fma_f32 v[174:175], v[174:175], v[14:15], v[12:13]
    v_cvt_pk_bf16_f32 v52, v168, v169
    v_cvt_pk_bf16_f32 v53, v170, v171
    v_cvt_pk_bf16_f32 v54, v172, v173
    v_cvt_pk_bf16_f32 v55, v174, v175
    ds_write_b128 v11, v[52:55] offset:38016
    buffer_load_dword v8, v5, s[88:91], 0 offen sc1
    s_cmp_eq_u32 s3, 3
    s_cbranch_scc1 L_a_nop1
    s_waitcnt vmcnt(16)
    v_lshlrev_b32 v96, 16, v56
    v_and_b32 v97, 0xffff0000, v56
    v_lshlrev_b32 v98, 16, v57
    v_and_b32 v99, 0xffff0000, v57
    v_lshlrev_b32 v100, 16, v58
    v_and_b32 v101, 0xffff0000, v58
    v_lshlrev_b32 v102, 16, v59
    v_and_b32 v103, 0xffff0000, v59
    v_pk_mul_f32 v[14:15], v[96:97], v[96:97]
    v_pk_add_f32 v[12:13], v[96:97], v[98:99]
    v_pk_fma_f32 v[14:15], v[98:99], v[98:99], v[14:15]
    v_pk_add_f32 v[12:13], v[12:13], v[100:101]
    v_pk_fma_f32 v[14:15], v[100:101], v[100:101], v[14:15]
    v_pk_add_f32 v[12:13], v[12:13], v[102:103]
    v_pk_fma_f32 v[14:15], v[102:103], v[102:103], v[14:15]
    s_waitcnt vmcnt(15)
    v_lshlrev_b32 v104, 16, v60
    v_and_b32 v105, 0xffff0000, v60
    v_lshlrev_b32 v106, 16, v61
    v_and_b32 v107, 0xffff0000, v61
    v_lshlrev_b32 v108, 16, v62
    v_and_b32 v109, 0xffff0000, v62
    v_lshlrev_b32 v110, 16, v63
    v_and_b32 v111, 0xffff0000, v63
    v_pk_add_f32 v[12:13], v[12:13], v[104:105]
    v_pk_fma_f32 v[14:15], v[104:105], v[104:105], v[14:15]
    v_pk_add_f32 v[12:13], v[12:13], v[106:107]
    v_pk_fma_f32 v[14:15], v[106:107], v[106:107], v[14:15]
    v_pk_add_f32 v[12:13], v[12:13], v[108:109]
    v_pk_fma_f32 v[14:15], v[108:109], v[108:109], v[14:15]
    v_pk_add_f32 v[12:13], v[12:13], v[110:111]
    v_pk_fma_f32 v[14:15], v[110:111], v[110:111], v[14:15]
    s_waitcnt vmcnt(14)
    v_lshlrev_b32 v112, 16, v64
    v_and_b32 v113, 0xffff0000, v64
    v_lshlrev_b32 v114, 16, v65
    v_and_b32 v115, 0xffff0000, v65
    v_lshlrev_b32 v116, 16, v66
    v_and_b32 v117, 0xffff0000, v66
    v_lshlrev_b32 v118, 16, v67
    v_and_b32 v119, 0xffff0000, v67
    v_pk_add_f32 v[12:13], v[12:13], v[112:113]
    v_pk_fma_f32 v[14:15], v[112:113], v[112:113], v[14:15]
    v_pk_add_f32 v[12:13], v[12:13], v[114:115]
    v_pk_fma_f32 v[14:15], v[114:115], v[114:115], v[14:15]
    v_pk_add_f32 v[12:13], v[12:13], v[116:117]
    v_pk_fma_f32 v[14:15], v[116:117], v[116:117], v[14:15]
    v_pk_add_f32 v[12:13], v[12:13], v[118:119]
    v_pk_fma_f32 v[14:15], v[118:119], v[118:119], v[14:15]
    s_waitcnt vmcnt(13)
    v_lshlrev_b32 v120, 16, v68
    v_and_b32 v121, 0xffff0000, v68
    v_lshlrev_b32 v122, 16, v69
    v_and_b32 v123, 0xffff0000, v69
    v_lshlrev_b32 v124, 16, v70
    v_and_b32 v125, 0xffff0000, v70
    v_lshlrev_b32 v126, 16, v71
    v_and_b32 v127, 0xffff0000, v71
    v_pk_add_f32 v[12:13], v[12:13], v[120:121]
    v_pk_fma_f32 v[14:15], v[120:121], v[120:121], v[14:15]
    v_pk_add_f32 v[12:13], v[12:13], v[122:123]
    v_pk_fma_f32 v[14:15], v[122:123], v[122:123], v[14:15]
    v_pk_add_f32 v[12:13], v[12:13], v[124:125]
    v_pk_fma_f32 v[14:15], v[124:125], v[124:125], v[14:15]
    v_pk_add_f32 v[12:13], v[12:13], v[126:127]
    v_pk_fma_f32 v[14:15], v[126:127], v[126:127], v[14:15]
    s_waitcnt vmcnt(12)
    v_lshlrev_b32 v128, 16, v72
    v_and_b32 v129, 0xffff0000, v72
    v_lshlrev_b32 v130, 16, v73
    v_and_b32 v131, 0xffff0000, v73
    v_lshlrev_b32 v132, 16, v74
    v_and_b32 v133, 0xffff0000, v74
    v_lshlrev_b32 v134, 16, v75
    v_and_b32 v135, 0xffff0000, v75
    v_pk_add_f32 v[12:13], v[12:13], v[128:129]
    v_pk_fma_f32 v[14:15], v[128:129], v[128:129], v[14:15]
    v_pk_add_f32 v[12:13], v[12:13], v[130:131]
    v_pk_fma_f32 v[14:15], v[130:131], v[130:131], v[14:15]
    v_pk_add_f32 v[12:13], v[12:13], v[132:133]
    v_pk_fma_f32 v[14:15], v[132:133], v[132:133], v[14:15]
    v_pk_add_f32 v[12:13], v[12:13], v[134:135]
    v_pk_fma_f32 v[14:15], v[134:135], v[134:135], v[14:15]
    s_waitcnt vmcnt(11)
    v_lshlrev_b32 v136, 16, v76
    v_and_b32 v137, 0xffff0000, v76
    v_lshlrev_b32 v138, 16, v77
    v_and_b32 v139, 0xffff0000, v77
    v_lshlrev_b32 v140, 16, v78
    v_and_b32 v141, 0xffff0000, v78
    v_lshlrev_b32 v142, 16, v79
    v_and_b32 v143, 0xffff0000, v79
    v_pk_add_f32 v[12:13], v[12:13], v[136:137]
    v_pk_fma_f32 v[14:15], v[136:137], v[136:137], v[14:15]
    v_pk_add_f32 v[12:13], v[12:13], v[138:139]
    v_pk_fma_f32 v[14:15], v[138:139], v[138:139], v[14:15]
    v_pk_add_f32 v[12:13], v[12:13], v[140:141]
    v_pk_fma_f32 v[14:15], v[140:141], v[140:141], v[14:15]
    v_pk_add_f32 v[12:13], v[12:13], v[142:143]
    v_pk_fma_f32 v[14:15], v[142:143], v[142:143], v[14:15]
    s_waitcnt vmcnt(10)
    v_lshlrev_b32 v144, 16, v80
    v_and_b32 v145, 0xffff0000, v80
    v_lshlrev_b32 v146, 16, v81
    v_and_b32 v147, 0xffff0000, v81
    v_lshlrev_b32 v148, 16, v82
    v_and_b32 v149, 0xffff0000, v82
    v_lshlrev_b32 v150, 16, v83
    v_and_b32 v151, 0xffff0000, v83
    v_pk_add_f32 v[12:13], v[12:13], v[144:145]
    v_pk_fma_f32 v[14:15], v[144:145], v[144:145], v[14:15]
    v_pk_add_f32 v[12:13], v[12:13], v[146:147]
    v_pk_fma_f32 v[14:15], v[146:147], v[146:147], v[14:15]
    v_pk_add_f32 v[12:13], v[12:13], v[148:149]
    v_pk_fma_f32 v[14:15], v[148:149], v[148:149], v[14:15]
    v_pk_add_f32 v[12:13], v[12:13], v[150:151]
    v_pk_fma_f32 v[14:15], v[150:151], v[150:151], v[14:15]
    s_waitcnt vmcnt(9)
    v_lshlrev_b32 v152, 16, v84
    v_and_b32 v153, 0xffff0000, v84
    v_lshlrev_b32 v154, 16, v85
    v_and_b32 v155, 0xffff0000, v85
    v_lshlrev_b32 v156, 16, v86
    v_and_b32 v157, 0xffff0000, v86
    v_lshlrev_b32 v158, 16, v87
    v_and_b32 v159, 0xffff0000, v87
    v_pk_add_f32 v[12:13], v[12:13], v[152:153]
    v_pk_fma_f32 v[14:15], v[152:153], v[152:153], v[14:15]
    v_pk_add_f32 v[12:13], v[12:13], v[154:155]
    v_pk_fma_f32 v[14:15], v[154:155], v[154:155], v[14:15]
    v_pk_add_f32 v[12:13], v[12:13], v[156:157]
    v_pk_fma_f32 v[14:15], v[156:157], v[156:157], v[14:15]
    v_pk_add_f32 v[12:13], v[12:13], v[158:159]
    v_pk_fma_f32 v[14:15], v[158:159], v[158:159], v[14:15]
    s_waitcnt vmcnt(8)
    v_lshlrev_b32 v160, 16, v88
    v_and_b32 v161, 0xffff0000, v88
    v_lshlrev_b32 v162, 16, v89
    v_and_b32 v163, 0xffff0000, v89
    v_lshlrev_b32 v164, 16, v90
    v_and_b32 v165, 0xffff0000, v90
    v_lshlrev_b32 v166, 16, v91
    v_and_b32 v167, 0xffff0000, v91
    v_pk_add_f32 v[12:13], v[12:13], v[160:161]
    v_pk_fma_f32 v[14:15], v[160:161], v[160:161], v[14:15]
    v_pk_add_f32 v[12:13], v[12:13], v[162:163]
    v_pk_fma_f32 v[14:15], v[162:163], v[162:163], v[14:15]
    v_pk_add_f32 v[12:13], v[12:13], v[164:165]
    v_pk_fma_f32 v[14:15], v[164:165], v[164:165], v[14:15]
    v_pk_add_f32 v[12:13], v[12:13], v[166:167]
    v_pk_fma_f32 v[14:15], v[166:167], v[166:167], v[14:15]
    s_waitcnt vmcnt(7)
    v_lshlrev_b32 v168, 16, v92
    v_and_b32 v169, 0xffff0000, v92
    v_lshlrev_b32 v170, 16, v93
    v_and_b32 v171, 0xffff0000, v93
    v_lshlrev_b32 v172, 16, v94
    v_and_b32 v173, 0xffff0000, v94
    v_lshlrev_b32 v174, 16, v95
    v_and_b32 v175, 0xffff0000, v95
    v_pk_add_f32 v[12:13], v[12:13], v[168:169]
    v_pk_fma_f32 v[14:15], v[168:169], v[168:169], v[14:15]
    v_pk_add_f32 v[12:13], v[12:13], v[170:171]
    v_pk_fma_f32 v[14:15], v[170:171], v[170:171], v[14:15]
    v_pk_add_f32 v[12:13], v[12:13], v[172:173]
    v_pk_fma_f32 v[14:15], v[172:173], v[172:173], v[14:15]
    v_pk_add_f32 v[12:13], v[12:13], v[174:175]
    v_pk_fma_f32 v[14:15], v[174:175], v[174:175], v[14:15]
    v_add_f32 v12, v12, v13
    v_add_f32 v14, v14, v15
    s_nop 0
    v_add_f32_dpp v12, v12, v12 quad_perm:[1,0,3,2] row_mask:0xf bank_mask:0xf
    v_add_f32_dpp v14, v14, v14 quad_perm:[1,0,3,2] row_mask:0xf bank_mask:0xf
    s_nop 0
    v_add_f32_dpp v12, v12, v12 quad_perm:[2,3,0,1] row_mask:0xf bank_mask:0xf
    v_add_f32_dpp v14, v14, v14 quad_perm:[2,3,0,1] row_mask:0xf bank_mask:0xf
    s_nop 0
    v_add_f32_dpp v12, v12, v12 row_half_mirror row_mask:0xf bank_mask:0xf
    v_add_f32_dpp v14, v14, v14 row_half_mirror row_mask:0xf bank_mask:0xf
    s_nop 0
    v_mul_f32 v12, 0x3acccccd, v12
    v_mul_f32 v14, 0x3acccccd, v14
    v_fma_f32 v14, -v12, v12, v14
    v_max_f32 v14, 0, v14
    v_add_f32 v14, 0x3727c5ac, v14
    v_rsq_f32 v14, v14
    s_nop 0
    v_mul_f32 v12, v12, v14
    v_mov_b32 v15, v14
    v_sub_f32 v12, 0, v12
    v_mov_b32 v13, v12
    v_pk_fma_f32 v[96:97], v[96:97], v[14:15], v[12:13]
    v_pk_fma_f32 v[98:99], v[98:99], v[14:15], v[12:13]
    v_pk_fma_f32 v[100:101], v[100:101], v[14:15], v[12:13]
    v_pk_fma_f32 v[102:103], v[102:103], v[14:15], v[12:13]
    v_cvt_pk_bf16_f32 v56, v96, v97
    v_cvt_pk_bf16_f32 v57, v98, v99
    v_cvt_pk_bf16_f32 v58, v100, v101
    v_cvt_pk_bf16_f32 v59, v102, v103
    ds_write_b128 v229, v[56:59] offset:0
    v_pk_fma_f32 v[104:105], v[104:105], v[14:15], v[12:13]
    v_pk_fma_f32 v[106:107], v[106:107], v[14:15], v[12:13]
    v_pk_fma_f32 v[108:109], v[108:109], v[14:15], v[12:13]
    v_pk_fma_f32 v[110:111], v[110:111], v[14:15], v[12:13]
    v_cvt_pk_bf16_f32 v60, v104, v105
    v_cvt_pk_bf16_f32 v61, v106, v107
    v_cvt_pk_bf16_f32 v62, v108, v109
    v_cvt_pk_bf16_f32 v63, v110, v111
    ds_write_b128 v229, v[60:63] offset:4224
    v_pk_fma_f32 v[112:113], v[112:113], v[14:15], v[12:13]
    v_pk_fma_f32 v[114:115], v[114:115], v[14:15], v[12:13]
    v_pk_fma_f32 v[116:117], v[116:117], v[14:15], v[12:13]
    v_pk_fma_f32 v[118:119], v[118:119], v[14:15], v[12:13]
    v_cvt_pk_bf16_f32 v64, v112, v113
    v_cvt_pk_bf16_f32 v65, v114, v115
    v_cvt_pk_bf16_f32 v66, v116, v117
    v_cvt_pk_bf16_f32 v67, v118, v119
    ds_write_b128 v229, v[64:67] offset:8448
    v_pk_fma_f32 v[120:121], v[120:121], v[14:15], v[12:13]
    v_pk_fma_f32 v[122:123], v[122:123], v[14:15], v[12:13]
    v_pk_fma_f32 v[124:125], v[124:125], v[14:15], v[12:13]
    v_pk_fma_f32 v[126:127], v[126:127], v[14:15], v[12:13]
    v_cvt_pk_bf16_f32 v68, v120, v121
    v_cvt_pk_bf16_f32 v69, v122, v123
    v_cvt_pk_bf16_f32 v70, v124, v125
    v_cvt_pk_bf16_f32 v71, v126, v127
    ds_write_b128 v229, v[68:71] offset:12672
    v_pk_fma_f32 v[128:129], v[128:129], v[14:15], v[12:13]
    v_pk_fma_f32 v[130:131], v[130:131], v[14:15], v[12:13]
    v_pk_fma_f32 v[132:133], v[132:133], v[14:15], v[12:13]
    v_pk_fma_f32 v[134:135], v[134:135], v[14:15], v[12:13]
    v_cvt_pk_bf16_f32 v72, v128, v129
    v_cvt_pk_bf16_f32 v73, v130, v131
    v_cvt_pk_bf16_f32 v74, v132, v133
    v_cvt_pk_bf16_f32 v75, v134, v135
    ds_write_b128 v229, v[72:75] offset:16896
    v_pk_fma_f32 v[136:137], v[136:137], v[14:15], v[12:13]
    v_pk_fma_f32 v[138:139], v[138:139], v[14:15], v[12:13]
    v_pk_fma_f32 v[140:141], v[140:141], v[14:15], v[12:13]
    v_pk_fma_f32 v[142:143], v[142:143], v[14:15], v[12:13]
    v_cvt_pk_bf16_f32 v76, v136, v137
    v_cvt_pk_bf16_f32 v77, v138, v139
    v_cvt_pk_bf16_f32 v78, v140, v141
    v_cvt_pk_bf16_f32 v79, v142, v143
    ds_write_b128 v229, v[76:79] offset:21120
    v_pk_fma_f32 v[144:145], v[144:145], v[14:15], v[12:13]
    v_pk_fma_f32 v[146:147], v[146:147], v[14:15], v[12:13]
    v_pk_fma_f32 v[148:149], v[148:149], v[14:15], v[12:13]
    v_pk_fma_f32 v[150:151], v[150:151], v[14:15], v[12:13]
    v_cvt_pk_bf16_f32 v80, v144, v145
    v_cvt_pk_bf16_f32 v81, v146, v147
    v_cvt_pk_bf16_f32 v82, v148, v149
    v_cvt_pk_bf16_f32 v83, v150, v151
    ds_write_b128 v229, v[80:83] offset:25344
    v_pk_fma_f32 v[152:153], v[152:153], v[14:15], v[12:13]
    v_pk_fma_f32 v[154:155], v[154:155], v[14:15], v[12:13]
    v_pk_fma_f32 v[156:157], v[156:157], v[14:15], v[12:13]
    v_pk_fma_f32 v[158:159], v[158:159], v[14:15], v[12:13]
    v_cvt_pk_bf16_f32 v84, v152, v153
    v_cvt_pk_bf16_f32 v85, v154, v155
    v_cvt_pk_bf16_f32 v86, v156, v157
    v_cvt_pk_bf16_f32 v87, v158, v159
    ds_write_b128 v229, v[84:87] offset:29568
    v_pk_fma_f32 v[160:161], v[160:161], v[14:15], v[12:13]
    v_pk_fma_f32 v[162:163], v[162:163], v[14:15], v[12:13]
    v_pk_fma_f32 v[164:165], v[164:165], v[14:15], v[12:13]
    v_pk_fma_f32 v[166:167], v[166:167], v[14:15], v[12:13]
    v_cvt_pk_bf16_f32 v88, v160, v161
    v_cvt_pk_bf16_f32 v89, v162, v163
    v_cvt_pk_bf16_f32 v90, v164, v165
    v_cvt_pk_bf16_f32 v91, v166, v167
    ds_write_b128 v229, v[88:91] offset:33792
    v_pk_fma_f32 v[168:169], v[168:169], v[14:15], v[12:13]
    v_pk_fma_f32 v[170:171], v[170:171], v[14:15], v[12:13]
    v_pk_fma_f32 v[172:173], v[172:173], v[14:15], v[12:13]
    v_pk_fma_f32 v[174:175], v[174:175], v[14:15], v[12:13]
    v_cvt_pk_bf16_f32 v92, v168, v169
    v_cvt_pk_bf16_f32 v93, v170, v171
    v_cvt_pk_bf16_f32 v94, v172, v173
    v_cvt_pk_bf16_f32 v95, v174, v175
    ds_write_b128 v229, v[92:95] offset:38016
L_a_nop1:
    s_waitcnt vmcnt(0)
    s_mov_b64 exec, 1
    v_mov_b32 v3, 3
    ds_write_b32 v223, v3
    s_mov_b64 exec, -1
    v_mov_b32 v152, v221
    v_mov_b32 v153, v222
    v_mov_b32 v154, v223
    ds_read_b32 v4, v6
    s_waitcnt lgkmcnt(0)
    v_cmp_gt_u32 vcc, 3, v4
    s_cmp_eq_u64 vcc, 0
    s_cbranch_scc0 L_psl_73
L_pok_71:
    ds_read_b64_tr_b16 v[176:177], v7 offset:0
    ds_read_b64_tr_b16 v[178:179], v7 offset:640
    ds_read_b64_tr_b16 v[180:181], v7 offset:2560
    ds_read_b64_tr_b16 v[182:183], v7 offset:3200
    ds_read_b64_tr_b16 v[184:185], v7 offset:5120
    ds_read_b64_tr_b16 v[186:187], v7 offset:5760
    ds_read_b64_tr_b16 v[188:189], v7 offset:7680
    ds_read_b64_tr_b16 v[190:191], v7 offset:8320
    ds_read_b64_tr_b16 v[192:193], v7 offset:10240
    ds_read_b64_tr_b16 v[194:195], v7 offset:10880
    ds_read_b64_tr_b16 v[196:197], v7 offset:12800
    ds_read_b64_tr_b16 v[198:199], v7 offset:13440
    ds_read_b64_tr_b16 v[200:201], v7 offset:15360
    ds_read_b64_tr_b16 v[202:203], v7 offset:16000
    ds_read_b64_tr_b16 v[204:205], v7 offset:17920
    ds_read_b64_tr_b16 v[206:207], v7 offset:18560
    ds_read_b64_tr_b16 v[208:209], v7 offset:20480
    ds_read_b64_tr_b16 v[210:211], v7 offset:21120
    ds_read_b64_tr_b16 v[212:213], v7 offset:23040
    ds_read_b64_tr_b16 v[214:215], v7 offset:23680
    s_mov_b64 exec, 1
    v_mov_b32 v3, 4
    ds_write_b32 v154, v3
    s_mov_b64 exec, -1
    v_mov_b32 v14, v224
    v_mov_b32 v155, 44
    v_add_u32 v15, 40960, v7
    s_setprio 2
    s_add_u32 s16, s86, 2621440
    s_addc_u32 s17, s87, 0
    s_mov_b32 s18, 196608
    s_mov_b32 s19, 0x00020000
    s_mov_b32 s20, s86
    s_mov_b32 s21, s87
    s_mov_b32 s22, 2621440
    s_mov_b32 s23, 0x00020000
    s_add_u32 s56, s86, 2818048
    s_addc_u32 s57, s87, 0
    s_mov_b32 s58, 65536
    s_mov_b32 s59, 0x00020000
    ds_read_b32 v4, v224
    s_waitcnt lgkmcnt(0)
    v_cmp_gt_u32 vcc, 1, v4
    s_cmp_eq_u64 vcc, 0
    s_cbranch_scc0 L_psl_76
L_pok_74:
    s_lshl_b32 s36, s4, 1
    s_mul_i32 s36, s36, 40960
    s_lshr_b32 s37, s24, 3
    s_mul_i32 s37, s37, 10240
    s_add_u32 s36, s36, s37
    s_and_b32 s37, s24, 7
    s_lshl_b32 s38, s37, 10
    s_add_u32 s38, s38, s36
    s_lshr_b32 s39, s37, 1
    s_lshl_b32 s39, s39, 9
    s_and_b32 s37, s37, 1
    s_lshl_b32 s37, s37, 3
    s_add_u32 s39, s39, s37
    s_add_u32 s39, s39, s36
    s_add_u32 s39, s39, 8192
    s_add_u32 s40, s38, 40960
    s_add_u32 s41, s39, 40960
    s_bfe_u32 s28, s2, 0x40003
    s_mul_i32 s28, s28, 12288
    s_mul_i32 s33, s3, 3072
    s_add_u32 s28, s28, s33
    s_lshl_b32 s43, s3, 6
    s_mov_b32 s35, 0
    v_lshlrev_b32 v9, 3, v1
    v_and_b32 v3, 31, v1
    v_min_u32 v3, 21, v3
    v_lshlrev_b32 v3, 4, v3
    v_lshrrev_b32 v4, 5, v1
    v_mul_u32_u24 v4, 384, v4
    v_add_u32 v11, v3, v4
    v_lshrrev_b32 v3, 2, v1
    v_lshlrev_b32 v3, 8, v3
    v_and_b32 v4, 3, v1
    v_lshl_add_u32 v13, v4, 4, v3
    ds_read_b128 v[96:99], v152 offset:0
    ds_read_b128 v[100:103], v153 offset:0
    ds_read_b128 v[104:107], v152 offset:1056
    ds_read_b128 v[108:111], v153 offset:1056
    ds_read_b128 v[112:115], v152 offset:2112
    ds_read_b128 v[116:119], v153 offset:2112
    s_waitcnt lgkmcnt(4)
    v_mfma_f32_32x32x16_bf16 v[120:135], v[176:179], v[96:99], 0
    v_mfma_f32_32x32x16_bf16 v[136:151], v[176:179], v[100:103], 0
    ds_read_b128 v[96:99], v152 offset:3168
    ds_read_b128 v[100:103], v153 offset:3168
    s_waitcnt lgkmcnt(4)
    v_mfma_f32_32x32x16_bf16 v[120:135], v[180:183], v[104:107], v[120:135]
    v_mfma_f32_32x32x16_bf16 v[136:151], v[180:183], v[108:111], v[136:151]
    ds_read_b128 v[104:107], v152 offset:4224
    ds_read_b128 v[108:111], v153 offset:4224
    s_waitcnt lgkmcnt(4)
    v_mfma_f32_32x32x16_bf16 v[120:135], v[184:187], v[112:115], v[120:135]
    v_mfma_f32_32x32x16_bf16 v[136:151], v[184:187], v[116:119], v[136:151]
    ds_read_b128 v[112:115], v152 offset:5280
    ds_read_b128 v[116:119], v153 offset:5280
    s_waitcnt lgkmcnt(4)
    v_mfma_f32_32x32x16_bf16 v[120:135], v[188:191], v[96:99], v[120:135]
    v_mfma_f32_32x32x16_bf16 v[136:151], v[188:191], v[100:103], v[136:151]
    ds_read_b128 v[96:99], v152 offset:6336
    ds_read_b128 v[100:103], v153 offset:6336
    s_waitcnt lgkmcnt(4)
    v_mfma_f32_32x32x16_bf16 v[120:135], v[192:195], v[104:107], v[120:135]
    v_mfma_f32_32x32x16_bf16 v[136:151], v[192:195], v[108:111], v[136:151]
    ds_read_b128 v[104:107], v152 offset:7392
    ds_read_b128 v[108:111], v153 offset:7392
    s_waitcnt lgkmcnt(4)
    v_mfma_f32_32x32x16_bf16 v[120:135], v[196:199], v[112:115], v[120:135]
    v_mfma_f32_32x32x16_bf16 v[136:151], v[196:199], v[116:119], v[136:151]
    ds_read_b128 v[112:115], v152 offset:8448
    ds_read_b128 v[116:119], v153 offset:8448
    s_waitcnt lgkmcnt(4)
    v_mfma_f32_32x32x16_bf16 v[120:135], v[200:203], v[96:99], v[120:135]
    v_mfma_f32_32x32x16_bf16 v[136:151], v[200:203], v[100:103], v[136:151]
    ds_read_b128 v[96:99], v152 offset:9504
    ds_read_b128 v[100:103], v153 offset:9504
    ds_read_b32 v4, v14
    s_waitcnt lgkmcnt(5)
    v_mfma_f32_32x32x16_bf16 v[120:135], v[204:207], v[104:107], v[120:135]
    v_mfma_f32_32x32x16_bf16 v[136:151], v[204:207], v[108:111], v[136:151]
    ds_read_b128 v[104:107], v152 offset:10560
    ds_read_b128 v[108:111], v153 offset:10560
    s_waitcnt lgkmcnt(2)
    v_cmp_gt_u32 vcc, 3, v4
    s_cmp_eq_u64 vcc, 0
    s_cbranch_scc0 L_psl_79
L_pok_77:
    ds_read_b64_tr_b16 v[216:217], v7 offset:25600
    ds_read_b64_tr_b16 v[218:219], v7 offset:26240
    ds_read_b64_tr_b16 v[220:221], v7 offset:28160
    ds_read_b64_tr_b16 v[222:223], v7 offset:28800
    ds_read_b64_tr_b16 v[224:225], v7 offset:30720
    ds_read_b64_tr_b16 v[226:227], v7 offset:31360
    v_mfma_f32_32x32x16_bf16 v[120:135], v[208:211], v[112:115], v[120:135]
    v_mfma_f32_32x32x16_bf16 v[136:151], v[208:211], v[116:119], v[136:151]
    ds_read_b128 v[112:115], v152 offset:11616
    ds_read_b128 v[116:119], v153 offset:11616
    ds_read_b64_tr_b16 v[228:229], v7 offset:33280
    ds_read_b64_tr_b16 v[230:231], v7 offset:33920
    ds_read_b64_tr_b16 v[232:233], v7 offset:35840
    ds_read_b64_tr_b16 v[234:235], v7 offset:36480
    ds_read_b64_tr_b16 v[236:237], v7 offset:38400
    ds_read_b64_tr_b16 v[238:239], v7 offset:39040
    v_mfma_f32_32x32x16_bf16 v[120:135], v[212:215], v[96:99], v[120:135]
    v_mfma_f32_32x32x16_bf16 v[136:151], v[212:215], v[100:103], v[136:151]
    ds_read_b128 v[96:99], v152 offset:12672
    ds_read_b128 v[100:103], v153 offset:12672
    ds_read_b64_tr_b16 v[240:241], v15 offset:0
    ds_read_b64_tr_b16 v[242:243], v15 offset:640
    ds_read_b64_tr_b16 v[244:245], v15 offset:2560
    ds_read_b64_tr_b16 v[246:247], v15 offset:3200
    ds_read_b64_tr_b16 v[248:249], v15 offset:5120
    ds_read_b64_tr_b16 v[250:251], v15 offset:5760
    s_waitcnt lgkmcnt(15)
    v_mfma_f32_32x32x16_bf16 v[120:135], v[216:219], v[104:107], v[120:135]
    v_mfma_f32_32x32x16_bf16 v[136:151], v[216:219], v[108:111], v[136:151]
    ds_read_b128 v[104:107], v152 offset:13728
    ds_read_b128 v[108:111], v153 offset:13728
    ds_read_b64_tr_b16 v[252:253], v15 offset:7680
    ds_read_b64_tr_b16 v[254:255], v15 offset:8320
    ds_read_b64_tr_b16 v[16:17], v15 offset:10240
    ds_read_b64_tr_b16 v[18:19], v15 offset:10880
    ds_read_b64_tr_b16 v[20:21], v15 offset:12800
    ds_read_b64_tr_b16 v[22:23], v15 offset:13440
    s_waitcnt lgkmcnt(15)
    v_mfma_f32_32x32x16_bf16 v[120:135], v[220:223], v[112:115], v[120:135]
    v_mfma_f32_32x32x16_bf16 v[136:151], v[220:223], v[116:119], v[136:151]
    ds_read_b128 v[112:115], v152 offset:14784
    ds_read_b128 v[116:119], v153 offset:14784
    ds_read_b64_tr_b16 v[24:25], v15 offset:15360
    ds_read_b64_tr_b16 v[26:27], v15 offset:16000
    ds_read_b64_tr_b16 v[28:29], v15 offset:17920
    ds_read_b64_tr_b16 v[30:31], v15 offset:18560
    ds_read_b64_tr_b16 v[32:33], v15 offset:20480
    ds_read_b64_tr_b16 v[34:35], v15 offset:21120
    s_waitcnt lgkmcnt(15)
    v_mfma_f32_32x32x16_bf16 v[120:135], v[224:227], v[96:99], v[120:135]
    v_mfma_f32_32x32x16_bf16 v[136:151], v[224:227], v[100:103], v[136:151]
    ds_read_b128 v[96:99], v152 offset:15840
    ds_read_b128 v[100:103], v153 offset:15840
    ds_read_b64_tr_b16 v[36:37], v15 offset:23040
    ds_read_b64_tr_b16 v[38:39], v15 offset:23680
    ds_read_b64_tr_b16 v[40:41], v15 offset:25600
    ds_read_b64_tr_b16 v[42:43], v15 offset:26240
    ds_read_b64_tr_b16 v[44:45], v15 offset:28160
    ds_read_b64_tr_b16 v[46:47], v15 offset:28800
    s_waitcnt lgkmcnt(15)
    v_mfma_f32_32x32x16_bf16 v[120:135], v[228:231], v[104:107], v[120:135]
    v_mfma_f32_32x32x16_bf16 v[136:151], v[228:231], v[108:111], v[136:151]
    ds_read_b128 v[104:107], v152 offset:16896
    ds_read_b128 v[108:111], v153 offset:16896
    ds_read_b64_tr_b16 v[48:49], v15 offset:30720
    ds_read_b64_tr_b16 v[50:51], v15 offset:31360
    ds_read_b64_tr_b16 v[52:53], v15 offset:33280
    ds_read_b64_tr_b16 v[54:55], v15 offset:33920
    s_waitcnt lgkmcnt(15)
    v_mfma_f32_32x32x16_bf16 v[120:135], v[232:235], v[112:115], v[120:135]
    v_mfma_f32_32x32x16_bf16 v[136:151], v[232:235], v[116:119], v[136:151]
    ds_read_b128 v[112:115], v152 offset:17952
    ds_read_b128 v[116:119], v153 offset:17952
    s_waitcnt lgkmcnt(14)
    v_mfma_f32_32x32x16_bf16 v[120:135], v[236:239], v[96:99], v[120:135]
    v_mfma_f32_32x32x16_bf16 v[136:151], v[236:239], v[100:103], v[136:151]
    ds_read_b128 v[96:99], v152 offset:19008
    ds_read_b128 v[100:103], v153 offset:19008
    s_waitcnt lgkmcnt(8)
    v_mfma_f32_32x32x16_bf16 v[120:135], v[240:243], v[104:107], v[120:135]
    v_mfma_f32_32x32x16_bf16 v[136:151], v[240:243], v[108:111], v[136:151]
    ds_read_b128 v[104:107], v152 offset:20064
    ds_read_b128 v[108:111], v153 offset:20064
    ds_read_b32 v4, v14
    s_waitcnt lgkmcnt(5)
    v_mfma_f32_32x32x16_bf16 v[120:135], v[244:247], v[112:115], v[120:135]
    v_mfma_f32_32x32x16_bf16 v[136:151], v[244:247], v[116:119], v[136:151]
    ds_read_b128 v[112:115], v152 offset:21120
    ds_read_b128 v[116:119], v153 offset:21120
    s_waitcnt lgkmcnt(2)
    v_cmp_gt_u32 vcc, 4, v4
    s_cmp_eq_u64 vcc, 0
    s_cbranch_scc0 L_psl_82
L_pok_80:
    ds_read_b64_tr_b16 v[56:57], v7 offset:0
    ds_read_b64_tr_b16 v[58:59], v7 offset:640
    ds_read_b64_tr_b16 v[60:61], v7 offset:2560
    ds_read_b64_tr_b16 v[62:63], v7 offset:3200
    v_mfma_f32_32x32x16_bf16 v[120:135], v[248:251], v[96:99], v[120:135]
    v_mfma_f32_32x32x16_bf16 v[136:151], v[248:251], v[100:103], v[136:151]
    ds_read_b128 v[96:99], v152 offset:22176
    ds_read_b128 v[100:103], v153 offset:22176
    ds_read_b64_tr_b16 v[64:65], v7 offset:5120
    ds_read_b64_tr_b16 v[66:67], v7 offset:5760
    ds_read_b64_tr_b16 v[68:69], v7 offset:7680
    ds_read_b64_tr_b16 v[70:71], v7 offset:8320
    v_mfma_f32_32x32x16_bf16 v[120:135], v[252:255], v[104:107], v[120:135]
    v_mfma_f32_32x32x16_bf16 v[136:151], v[252:255], v[108:111], v[136:151]
    ds_read_b128 v[104:107], v152 offset:23232
    ds_read_b128 v[108:111], v153 offset:23232
    ds_read_b64_tr_b16 v[72:73], v7 offset:10240
    ds_read_b64_tr_b16 v[74:75], v7 offset:10880
    ds_read_b64_tr_b16 v[76:77], v7 offset:12800
    ds_read_b64_tr_b16 v[78:79], v7 offset:13440
    s_waitcnt lgkmcnt(15)
    v_mfma_f32_32x32x16_bf16 v[120:135], v[16:19], v[112:115], v[120:135]
    v_mov_b32 v156, 0
    v_mov_b32 v157, 0
    v_mov_b32 v158, 0
    v_mov_b32 v159, 0
    v_mov_b32 v160, 0
    v_mfma_f32_32x32x16_bf16 v[136:151], v[16:19], v[116:119], v[136:151]
    ds_read_b128 v[112:115], v152 offset:24288
    ds_read_b128 v[116:119], v153 offset:24288
    ds_read_b64_tr_b16 v[80:81], v7 offset:15360
    ds_read_b64_tr_b16 v[82:83], v7 offset:16000
    ds_read_b64_tr_b16 v[84:85], v7 offset:17920
    ds_read_b64_tr_b16 v[86:87], v7 offset:18560
    s_waitcnt lgkmcnt(15)
    v_mfma_f32_32x32x16_bf16 v[120:135], v[20:23], v[96:99], v[120:135]
    v_mov_b32 v161, 0
    v_mov_b32 v162, 0
    v_mov_b32 v163, 0
    v_mov_b32 v164, 0
    v_mov_b32 v165, 0
    v_mfma_f32_32x32x16_bf16 v[136:151], v[20:23], v[100:103], v[136:151]
    ds_read_b128 v[96:99], v152 offset:25344
    ds_read_b128 v[100:103], v153 offset:25344
    ds_read_b64_tr_b16 v[88:89], v7 offset:20480
    ds_read_b64_tr_b16 v[90:91], v7 offset:21120
    ds_read_b64_tr_b16 v[92:93], v7 offset:23040
    ds_read_b64_tr_b16 v[94:95], v7 offset:23680
    s_mov_b64 exec, 1
    v_mov_b32 v3, 8
    ds_write_b32 v154, v3
    s_mov_b64 exec, -1
    s_waitcnt lgkmcnt(15)
    v_mfma_f32_32x32x16_bf16 v[120:135], v[24:27], v[104:107], v[120:135]
    v_mov_b32 v166, 0
    v_mov_b32 v167, 0
    v_mov_b32 v168, 0
    v_mov_b32 v169, 0
    v_mov_b32 v170, 0
    v_mfma_f32_32x32x16_bf16 v[136:151], v[24:27], v[108:111], v[136:151]
    ds_read_b128 v[104:107], v152 offset:26400
    ds_read_b128 v[108:111], v153 offset:26400
    s_waitcnt lgkmcnt(13)
    v_mfma_f32_32x32x16_bf16 v[120:135], v[28:31], v[112:115], v[120:135]
    v_mov_b32 v171, 0
    v_mov_b32 v172, 0
    v_mov_b32 v173, 0
    v_mov_b32 v174, 0
    v_mov_b32 v175, 0
    v_mfma_f32_32x32x16_bf16 v[136:151], v[28:31], v[116:119], v[136:151]
    ds_read_b128 v[112:115], v152 offset:27456
    ds_read_b128 v[116:119], v153 offset:27456
    s_mov_b32 s63, 16384
L_tlp_84:
    v_readfirstlane_b32 s62, v8
    s_cmp_lg_u32 s62, 0
    s_cbranch_scc1 L_tok_83
    s_sleep 4
    buffer_load_dword v8, v5, s[88:91], 0 offen sc1
    s_waitcnt vmcnt(0)
    s_sub_u32 s63, s63, 1
    s_cbranch_scc0 L_tlp_84
L_tok_83:
    s_waitcnt lgkmcnt(9)
    v_mfma_f32_32x32x16_bf16 v[120:135], v[32:35], v[96:99], v[120:135]
    v_mov_b32 v176, 0
    v_mov_b32 v177, 0
    v_mov_b32 v178, 0
    v_mov_b32 v179, 0
    v_mov_b32 v180, 0
    v_mfma_f32_32x32x16_bf16 v[136:151], v[32:35], v[100:103], v[136:151]
    ds_read_b128 v[96:99], v152 offset:28512
    ds_read_b128 v[100:103], v153 offset:28512
    s_waitcnt lgkmcnt(4)
    v_mfma_f32_32x32x16_bf16 v[120:135], v[36:39], v[104:107], v[120:135]
    v_mov_b32 v181, 0
    v_mov_b32 v182, 0
    v_mov_b32 v183, 0
    v_mov_b32 v184, 0
    v_mov_b32 v185, 0
    v_mfma_f32_32x32x16_bf16 v[136:151], v[36:39], v[108:111], v[136:151]
    ds_read_b128 v[104:107], v152 offset:29568
    ds_read_b128 v[108:111], v153 offset:29568
    s_waitcnt lgkmcnt(4)
    v_mfma_f32_32x32x16_bf16 v[120:135], v[40:43], v[112:115], v[120:135]
    v_mov_b32 v186, 0
    v_mov_b32 v187, 0
    v_mov_b32 v188, 0
    v_mov_b32 v189, 0
    v_mov_b32 v190, 0
    v_mfma_f32_32x32x16_bf16 v[136:151], v[40:43], v[116:119], v[136:151]
    ds_read_b128 v[112:115], v152 offset:30624
    ds_read_b128 v[116:119], v153 offset:30624
    s_waitcnt lgkmcnt(4)
    v_mfma_f32_32x32x16_bf16 v[120:135], v[44:47], v[96:99], v[120:135]
    v_mov_b32 v191, 0
    v_mov_b32 v192, 0
    v_mov_b32 v193, 0
    v_mov_b32 v194, 0
    v_mov_b32 v195, 0
    v_mfma_f32_32x32x16_bf16 v[136:151], v[44:47], v[100:103], v[136:151]
    ds_read_b128 v[96:99], v152 offset:31680
    ds_read_b128 v[100:103], v153 offset:31680
    s_waitcnt lgkmcnt(4)
    v_mfma_f32_32x32x16_bf16 v[120:135], v[48:51], v[104:107], v[120:135]
    v_mov_b32 v196, 0
    v_mov_b32 v197, 0
    v_mov_b32 v198, 0
    v_mov_b32 v199, 0
    v_mov_b32 v200, 0
    v_mfma_f32_32x32x16_bf16 v[136:151], v[48:51], v[108:111], v[136:151]
    ds_read_b128 v[104:107], v152 offset:32736
    ds_read_b128 v[108:111], v153 offset:32736
    s_waitcnt lgkmcnt(4)
    v_mfma_f32_32x32x16_bf16 v[120:135], v[52:55], v[112:115], v[120:135]
    v_mov_b32 v201, 0
    v_mov_b32 v202, 0
    v_mov_b32 v203, 0
    v_mov_b32 v204, 0
    v_mov_b32 v205, 0
    v_mfma_f32_32x32x16_bf16 v[136:151], v[52:55], v[116:119], v[136:151]
    ds_read_b128 v[112:115], v152 offset:33792
    ds_read_b128 v[116:119], v153 offset:33792
    ds_read_b32 v4, v6
    s_waitcnt lgkmcnt(5)
    v_mfma_f32_32x32x16_bf16 v[120:135], v[56:59], v[96:99], v[120:135]
    v_mov_b32 v206, 0
    v_mov_b32 v207, 0
    v_mov_b32 v208, 0
    v_mov_b32 v209, 0
    v_mov_b32 v210, 0
    v_mfma_f32_32x32x16_bf16 v[136:151], v[56:59], v[100:103], v[136:151]
    ds_read_b128 v[96:99], v152 offset:34848
    ds_read_b128 v[100:103], v153 offset:34848
    s_waitcnt lgkmcnt(5)
    v_mfma_f32_32x32x16_bf16 v[120:135], v[60:63], v[104:107], v[120:135]
    v_mov_b32 v211, 0
    v_mov_b32 v212, 0
    v_mov_b32 v213, 0
    v_mov_b32 v214, 0
    v_mov_b32 v215, 0
    v_mfma_f32_32x32x16_bf16 v[136:151], v[60:63], v[108:111], v[136:151]
    ds_read_b128 v[104:107], v152 offset:35904
    ds_read_b128 v[108:111], v153 offset:35904
    s_waitcnt lgkmcnt(4)
    v_cmp_gt_u32 vcc, 8, v4
    s_cmp_eq_u64 vcc, 0
    s_cbranch_scc0 L_psl_87
L_pok_85:
    buffer_load_dword v8, v13, s[56:59], s43 offen sc1
    v_mfma_f32_32x32x16_bf16 v[120:135], v[64:67], v[112:115], v[120:135]
    v_mov_b32 v216, 0
    v_mov_b32 v217, 0
    v_mov_b32 v218, 0
    v_mov_b32 v219, 0
    v_mov_b32 v220, 0
    v_mfma_f32_32x32x16_bf16 v[136:151], v[64:67], v[116:119], v[136:151]
    ds_read_b128 v[112:115], v152 offset:36960
    ds_read_b128 v[116:119], v153 offset:36960
    s_waitcnt lgkmcnt(4)
    v_mfma_f32_32x32x16_bf16 v[120:135], v[68:71], v[96:99], v[120:135]
    v_mov_b32 v221, 0
    v_mov_b32 v222, 0
    v_mov_b32 v223, 0
    v_mov_b32 v224, 0
    v_mov_b32 v225, 0
    v_mfma_f32_32x32x16_bf16 v[136:151], v[68:71], v[100:103], v[136:151]
    ds_read_b128 v[96:99], v152 offset:38016
    ds_read_b128 v[100:103], v153 offset:38016
    s_waitcnt lgkmcnt(4)
    v_mfma_f32_32x32x16_bf16 v[120:135], v[72:75], v[104:107], v[120:135]
    v_mov_b32 v226, 0
    v_mov_b32 v227, 0
    v_mov_b32 v228, 0
    v_mov_b32 v229, 0
    v_mov_b32 v230, 0
    v_mfma_f32_32x32x16_bf16 v[136:151], v[72:75], v[108:111], v[136:151]
    ds_read_b128 v[104:107], v152 offset:39072
    ds_read_b128 v[108:111], v153 offset:39072
    s_waitcnt lgkmcnt(4)
    v_mfma_f32_32x32x16_bf16 v[120:135], v[76:79], v[112:115], v[120:135]
    v_mov_b32 v231, 0
    v_mov_b32 v232, 0
    v_mov_b32 v233, 0
    v_mov_b32 v234, 0
    v_mov_b32 v235, 0
    v_mfma_f32_32x32x16_bf16 v[136:151], v[76:79], v[116:119], v[136:151]
    ds_read_b128 v[112:115], v152 offset:40128
    ds_read_b128 v[116:119], v153 offset:40128
    s_waitcnt lgkmcnt(4)
    v_mfma_f32_32x32x16_bf16 v[120:135], v[80:83], v[96:99], v[120:135]
    v_mov_b32 v236, 0
    v_mov_b32 v237, 0
    v_mov_b32 v238, 0
    v_mov_b32 v239, 0
    v_mov_b32 v240, 0
    v_mfma_f32_32x32x16_bf16 v[136:151], v[80:83], v[100:103], v[136:151]
    ds_read_b128 v[96:99], v152 offset:41184
    ds_read_b128 v[100:103], v153 offset:41184
    s_waitcnt lgkmcnt(4)
    v_mfma_f32_32x32x16_bf16 v[120:135], v[84:87], v[104:107], v[120:135]
    v_mov_b32 v241, 0
    v_mov_b32 v242, 0
    v_mov_b32 v243, 0
    v_mov_b32 v244, 0
    v_mov_b32 v245, 0
    v_mfma_f32_32x32x16_bf16 v[136:151], v[84:87], v[108:111], v[136:151]
    s_waitcnt lgkmcnt(2)
    v_mfma_f32_32x32x16_bf16 v[120:135], v[88:91], v[112:115], v[120:135]
    v_mov_b32 v246, 0
    v_mov_b32 v247, 0
    v_mov_b32 v248, 0
    v_mov_b32 v249, 0
    v_mov_b32 v250, 0
    v_mfma_f32_32x32x16_bf16 v[136:151], v[88:91], v[116:119], v[136:151]
    s_waitcnt lgkmcnt(0)
    v_mfma_f32_32x32x16_bf16 v[120:135], v[92:95], v[96:99], v[120:135]
    v_mov_b32 v251, 0
    v_mov_b32 v252, 0
    v_mov_b32 v253, 0
    v_mov_b32 v254, 0
    v_mov_b32 v255, 0
    v_mfma_f32_32x32x16_bf16 v[136:151], v[92:95], v[100:103], v[136:151]
    v_mov_b32 v7, s30
    v_mov_b32 v10, v13
    v_cmp_gt_u32 vcc, 32, v1
    v_mov_b32 v3, 0x3ea52b5c
    s_mov_b32 s31, 0x3ea52b5c
    s_mul_i32 s29, s3, 6272
    v_cndmask_b32 v155, 0, v3, vcc
    s_mov_b64 s[60:61], vcc
    s_add_u32 s29, s29, 110336
    v_add_u32 v12, s29, v2
    v_add_u32 v4, s29, v9
    s_add_u32 s32, s3, 1
    s_and_b32 s32, s32, 3
    s_mul_i32 s32, s32, 6272
    s_add_u32 s32, s32, 110336
    v_add_u32 v13, s32, v2
    s_add_u32 s32, s3, 2
    s_and_b32 s32, s32, 3
    s_mul_i32 s32, s32, 6272
    s_add_u32 s32, s32, 110336
    v_add_u32 v14, s32, v2
    s_add_u32 s32, s3, 3
    s_and_b32 s32, s32, 3
    s_mul_i32 s32, s32, 6272
    s_add_u32 s32, s32, 110336
    v_add_u32 v15, s32, v2
    v_mul_f32 v120, s31, v120
    v_mul_f32 v121, s31, v121
    v_mul_f32 v122, s31, v122
    v_mul_f32 v123, s31, v123
    v_mul_f32 v124, s31, v124
    v_mul_f32 v125, s31, v125
    v_mul_f32 v126, s31, v126
    v_mul_f32 v127, s31, v127
    v_mul_f32 v128, v155, v128
    v_mul_f32 v129, v155, v129
    v_mul_f32 v130, v155, v130
    v_mul_f32 v131, v155, v131
    v_cvt_pk_bf16_f32 v40, v120, v121
    v_cvt_pk_bf16_f32 v41, v122, v123
    v_cvt_pk_bf16_f32 v42, v124, v125
    v_cvt_pk_bf16_f32 v43, v126, v127
    v_cvt_pk_bf16_f32 v60, v128, v129
    v_cvt_pk_bf16_f32 v61, v130, v131
    ds_write_b128 v12, v[40:43] offset:0
    ds_write_b64 v4, v[60:61] offset:1024
    v_mul_f32 v136, s31, v136
    v_mul_f32 v137, s31, v137
    v_mul_f32 v138, s31, v138
    v_mul_f32 v139, s31, v139
    v_mul_f32 v140, s31, v140
    v_mul_f32 v141, s31, v141
    v_mul_f32 v142, s31, v142
    v_mul_f32 v143, s31, v143
    v_mul_f32 v144, v155, v144
    v_mul_f32 v145, v155, v145
    v_mul_f32 v146, v155, v146
    v_mul_f32 v147, v155, v147
    v_cvt_pk_bf16_f32 v44, v136, v137
    v_cvt_pk_bf16_f32 v45, v138, v139
    v_cvt_pk_bf16_f32 v46, v140, v141
    v_cvt_pk_bf16_f32 v47, v142, v143
    v_cvt_pk_bf16_f32 v62, v144, v145
    v_cvt_pk_bf16_f32 v63, v146, v147
    ds_write_b128 v12, v[44:47] offset:1536
    ds_write_b64 v4, v[62:63] offset:2560
    s_mov_b64 exec, 1
    v_mov_b32 v3, 9
    ds_write_b32 v7, v3
    s_mov_b64 exec, -1
    s_cmp_eq_u32 s35, 1
    s_cbranch_scc1 L_a_kvld
    s_waitcnt vmcnt(0)
    v_cmp_ne_u32 vcc, s62, v8
    s_cmp_eq_u64 vcc, 0
    s_cbranch_scc0 L_a_kvld
    buffer_load_dwordx4 v[112:115], v2, s[16:19], s28 offen sc1
    buffer_load_dwordx2 v[124:125], v9, s[16:19], s28 offen offset:1024 sc1
    buffer_load_dwordx4 v[130:133], v11, s[16:19], s28 offen offset:1536 sc1
    buffer_load_dwordx4 v[134:137], v11, s[16:19], s28 offen offset:2304 sc1
    s_add_u32 s28, s28, 12288
    s_sub_u32 s27, s28, 196608
    s_cmp_ge_u32 s28, 196608
    s_cselect_b32 s28, s27, s28
    buffer_load_dwordx4 v[116:119], v2, s[16:19], s28 offen sc1
    buffer_load_dwordx2 v[126:127], v9, s[16:19], s28 offen offset:1024 sc1
    buffer_load_dwordx4 v[138:141], v11, s[16:19], s28 offen offset:1536 sc1
    buffer_load_dwordx4 v[142:145], v11, s[16:19], s28 offen offset:2304 sc1
    s_add_u32 s28, s28, 12288
    s_sub_u32 s27, s28, 196608
    s_cmp_ge_u32 s28, 196608
    s_cselect_b32 s28, s27, s28
    s_mov_b32 s35, 1
L_a_kvld:
    ds_read_b32 v3, v6
    s_waitcnt lgkmcnt(0)
    v_cmp_gt_u32 vcc, 9, v3
    s_cmp_eq_u64 vcc, 0
    s_cbranch_scc0 L_psl_90
L_pok_88:
    ds_read_b128 v[16:19], v13 offset:0
    ds_read_b128 v[20:23], v13 offset:1536
    v_sub_u32 v3, v13, v9
    ds_read_b64 v[48:49], v3 offset:1024
    ds_read_b64 v[50:51], v3 offset:2560
    ds_read_b128 v[24:27], v14 offset:0
    ds_read_b128 v[28:31], v14 offset:1536
    v_sub_u32 v3, v14, v9
    ds_read_b64 v[52:53], v3 offset:1024
    ds_read_b64 v[54:55], v3 offset:2560
    ds_read_b128 v[32:35], v15 offset:0
    ds_read_b128 v[36:39], v15 offset:1536
    v_sub_u32 v3, v15, v9
    ds_read_b64 v[56:57], v3 offset:1024
    ds_read_b64 v[58:59], v3 offset:2560
    s_mov_b64 exec, 1
    v_mov_b32 v3, 10
    ds_write_b32 v7, v3
    s_mov_b64 exec, -1
    s_cmp_eq_u32 s35, 1
    s_cbranch_scc1 L_a_kvgo
    s_mov_b32 s63, 16384
L_glp_92:
    buffer_load_dword v8, v10, s[56:59], s43 offen offset:0 sc1
    s_waitcnt vmcnt(0)
    v_xor_b32 v8, s62, v8
    v_cmp_ne_u32 vcc, 0, v8
    s_cmp_eq_u64 vcc, 0
    s_cbranch_scc1 L_gok_91
    s_sleep 4
    s_sub_u32 s63, s63, 1
    s_cbranch_scc0 L_glp_92
L_gok_91:
    buffer_load_dwordx4 v[112:115], v2, s[16:19], s28 offen sc1
    buffer_load_dwordx2 v[124:125], v9, s[16:19], s28 offen offset:1024 sc1
    buffer_load_dwordx4 v[130:133], v11, s[16:19], s28 offen offset:1536 sc1
    buffer_load_dwordx4 v[134:137], v11, s[16:19], s28 offen offset:2304 sc1
    s_add_u32 s28, s28, 12288
    s_sub_u32 s27, s28, 196608
    s_cmp_ge_u32 s28, 196608
    s_cselect_b32 s28, s27, s28
    buffer_load_dwordx4 v[116:119], v2, s[16:19], s28 offen sc1
    buffer_load_dwordx2 v[126:127], v9, s[16:19], s28 offen offset:1024 sc1
    buffer_load_dwordx4 v[138:141], v11, s[16:19], s28 offen offset:1536 sc1
    buffer_load_dwordx4 v[142:145], v11, s[16:19], s28 offen offset:2304 sc1
    s_add_u32 s28, s28, 12288
    s_sub_u32 s27, s28, 196608
    s_cmp_ge_u32 s28, 196608
    s_cselect_b32 s28, s27, s28
L_a_kvgo:
    s_mov_b32 s92, s80
    s_mov_b32 s93, s81
    s_mov_b32 s94, 1966080
    s_mov_b32 s95, 0x00020000
    s_mov_b32 s96, s72
    s_mov_b32 s97, s73
    s_mov_b32 s98, 819200
    s_mov_b32 s99, 0x00020000
    v_mul_u32_u24 v3, 171, v1
    v_lshrrev_b32 v3, 9, v3
    v_mul_u32_u24 v154, 3, v3
    v_sub_u32 v154, v1, v154
    v_lshlrev_b32 v154, 7, v154
    v_min_u32 v154, 316, v154
    v_min_u32 v3, 7, v3
    v_mul_u32_u24 v3, 1280, v3
    v_add_u32 v154, v154, v3
    s_and_b32 s32, s4, 15
    s_lshl_b32 s32, s32, 2
    s_add_u32 s32, s32, s3
    s_and_b32 s37, s5, 3
    s_mul_i32 s37, s37, 320
    s_mul_i32 s33, s32, 6400
    s_add_u32 s33, s33, s37
    s_mul_i32 s35, s32, 10240
    s_add_u32 s35, s35, s37
    s_add_u32 s12, s86, 3145728
    s_addc_u32 s13, s87, 0
    s_mov_b32 s14, 6291456
    s_mov_b32 s15, 0x00020000
    s_mul_i32 s25, s4, 196608
    s_mul_i32 s26, s5, 12288
    s_add_u32 s25, s25, s26
    s_mul_i32 s26, s3, 3072
    s_add_u32 s25, s25, s26
    s_add_u32 s26, s25, 98304
    v_mov_b32 v104, 0
    v_mov_b32 v146, 0
    v_mov_b32 v105, 0
    v_mov_b32 v147, 0
    v_mov_b32 v106, 0
    v_mov_b32 v148, 0
    v_mov_b32 v107, 0
    v_mov_b32 v149, 0
    v_mov_b32 v108, 0
    v_mov_b32 v150, 0
    v_mov_b32 v109, 0
    v_mov_b32 v151, 0
    v_mov_b32 v110, 0
    v_mov_b32 v152, 0
    v_mov_b32 v111, 0
    v_mov_b32 v153, 0
    s_mov_b32 s42, 0x71800000
    v_lshlrev_b32 v4, 2, v1
    s_add_u32 s32, s3, 1
    s_and_b32 s32, s32, 3
    s_lshl_b32 s32, s32, 9
    s_add_u32 s32, s32, 161024
    v_add_u32 v13, s32, v4
    s_add_u32 s32, s3, 2
    s_and_b32 s32, s32, 3
    s_lshl_b32 s32, s32, 9
    s_add_u32 s32, s32, 161024
    v_add_u32 v14, s32, v4
    s_add_u32 s32, s3, 3
    s_and_b32 s32, s32, 3
    s_lshl_b32 s32, s32, 9
    s_add_u32 s32, s32, 161024
    v_add_u32 v15, s32, v4
    s_lshl_b32 s32, s3, 9
    s_add_u32 s32, s32, 161024
    v_add_u32 v12, s32, v4
    s_waitcnt vmcnt(6)
    v_mfma_f32_32x32x16_bf16 v[64:79], v[112:115], v[40:43], 0
    v_mfma_f32_32x32x8_bf16 v[64:79], v[124:125], v[60:61], v[64:79]
    v_mfma_f32_32x32x16_bf16 v[80:95], v[112:115], v[44:47], 0
    v_mfma_f32_32x32x8_bf16 v[80:95], v[124:125], v[62:63], v[80:95]
    s_nop 7
    s_nop 1
    v_max3_f32 v3, v64, v65, v66
    v_max3_f32 v3, v3, v67, v68
    v_max3_f32 v3, v3, v69, v70
    v_max3_f32 v3, v3, v71, v72
    v_max3_f32 v3, v3, v73, v74
    v_max3_f32 v3, v3, v75, v76
    v_max3_f32 v3, v3, v77, v78
    v_max_f32 v3, v3, v79
    v_mov_b32 v4, v3
    s_nop 1
    v_permlane32_swap_b32 v3, v4
    s_nop 1
    v_max_f32 v3, v3, v4
    v_sub_f32 v3, 0, v3
    v_cvt_pk_bf16_f32 v4, v3, v3
    v_lshlrev_b32 v4, 16, v4
    v_sub_f32 v4, v3, v4
    v_cvt_pk_bf16_f32 v4, v3, v4
    v_cndmask_b32 v60, v4, v60, s[60:61]
    ds_write_b32 v12, v60 offset:0
    v_max3_f32 v3, v80, v81, v82
    v_max3_f32 v3, v3, v83, v84
    v_max3_f32 v3, v3, v85, v86
    v_max3_f32 v3, v3, v87, v88
    v_max3_f32 v3, v3, v89, v90
    v_max3_f32 v3, v3, v91, v92
    v_max3_f32 v3, v3, v93, v94
    v_max_f32 v3, v3, v95
    v_mov_b32 v4, v3
    s_nop 1
    v_permlane32_swap_b32 v3, v4
    s_nop 1
    v_max_f32 v3, v3, v4
    v_sub_f32 v3, 0, v3
    v_cvt_pk_bf16_f32 v4, v3, v3
    v_lshlrev_b32 v4, 16, v4
    v_sub_f32 v4, v3, v4
    v_cvt_pk_bf16_f32 v4, v3, v4
    v_cndmask_b32 v62, v4, v62, s[60:61]
    ds_write_b32 v12, v62 offset:256
    s_waitcnt lgkmcnt(0)
    s_mov_b64 exec, 1
    v_mov_b32 v8, 11
    ds_write_b32 v7, v8
    s_mov_b64 exec, -1
    ds_read_b32 v8, v6
    s_waitcnt lgkmcnt(0)
    v_cmp_gt_u32 vcc, 11, v8
    s_cmp_eq_u64 vcc, 0
    s_cbranch_scc0 L_psl_95
L_pok_93:
    ds_read_b32 v48, v13 offset:0
    ds_read_b32 v50, v13 offset:256
    ds_read_b32 v52, v14 offset:0
    ds_read_b32 v54, v14 offset:256
    ds_read_b32 v56, v15 offset:0
    ds_read_b32 v58, v15 offset:256
    s_add_u32 s32, s3, 1
    s_and_b32 s32, s32, 3
    s_mul_i32 s32, s32, 18432
    s_add_u32 s32, s32, 256
    v_add_u32 v13, s32, v2
    s_add_u32 s32, s3, 2
    s_and_b32 s32, s32, 3
    s_mul_i32 s32, s32, 18432
    s_add_u32 s32, s32, 6400
    v_add_u32 v14, s32, v2
    s_add_u32 s32, s3, 3
    s_and_b32 s32, s32, 3
    s_mul_i32 s32, s32, 18432
    s_add_u32 s32, s32, 12544
    v_add_u32 v15, s32, v2
    v_add_u32 v12, 16, v6
    s_mul_i32 s32, s3, 18432
    s_add_u32 s32, s32, 256
    v_add_u32 v10, s32, v2
    v_mfma_f32_32x32x16_bf16 v[64:79], v[112:115], v[16:19], 0
    s_waitcnt lgkmcnt(0)
    v_mfma_f32_32x32x8_bf16 v[64:79], v[124:125], v[48:49], v[64:79]
    s_mov_b32 s34, 0
    s_nop 7
    s_nop 1
.p2align 6
L_a_loop:
    v_mfma_f32_32x32x16_bf16 v[80:95], v[112:115], v[20:23], 0
    v_exp_f32 v64, v64
    v_exp_f32 v65, v65
    v_exp_f32 v66, v66
    v_mfma_f32_32x32x8_bf16 v[80:95], v[124:125], v[50:51], v[80:95]
    v_exp_f32 v67, v67
    v_exp_f32 v68, v68
    v_cvt_pk_bf16_f32 v96, v64, v65
    v_exp_f32 v69, v69
    v_exp_f32 v70, v70
    v_cvt_pk_bf16_f32 v97, v66, v67
    v_exp_f32 v71, v71
    v_cvt_pk_bf16_f32 v98, v68, v69
    v_exp_f32 v72, v72
    v_mfma_f32_32x32x16_bf16 v[240:255], v[146:149], v[104:107], v[240:255]
    v_exp_f32 v73, v73
    v_exp_f32 v74, v74
    v_cvt_pk_bf16_f32 v99, v70, v71
    v_cvt_pk_bf16_f32 v100, v72, v73
    v_mfma_f32_32x32x16_bf16 v[240:255], v[150:153], v[108:111], v[240:255]
    v_exp_f32 v75, v75
    s_cmp_eq_u32 s34, 0
    s_cbranch_scc1 L_cw_96
L_cr_97:
    v_exp_f32 v76, v76
    v_exp_f32 v77, v77
    v_cvt_pk_bf16_f32 v101, v74, v75
    v_exp_f32 v78, v78
    v_exp_f32 v79, v79
    v_cvt_pk_bf16_f32 v102, v76, v77
    v_cvt_pk_bf16_f32 v103, v78, v79
    s_waitcnt vmcnt(4)
    v_mfma_f32_32x32x16_bf16 v[64:79], v[112:115], v[24:27], 0
    v_exp_f32 v80, v80
    v_exp_f32 v81, v81
    v_exp_f32 v82, v82
    v_mfma_f32_32x32x8_bf16 v[64:79], v[124:125], v[52:53], v[64:79]
    v_exp_f32 v83, v83
    v_exp_f32 v84, v84
    v_cvt_pk_bf16_f32 v104, v80, v81
    v_exp_f32 v85, v85
    v_exp_f32 v86, v86
    v_cvt_pk_bf16_f32 v105, v82, v83
    v_exp_f32 v87, v87
    v_cvt_pk_bf16_f32 v106, v84, v85
    v_exp_f32 v88, v88
    v_mfma_f32_32x32x16_bf16 v[156:171], v[130:133], v[96:99], v[156:171]
    v_exp_f32 v89, v89
    v_exp_f32 v90, v90
    v_cvt_pk_bf16_f32 v107, v86, v87
    v_cvt_pk_bf16_f32 v108, v88, v89
    v_mfma_f32_32x32x16_bf16 v[156:171], v[134:137], v[100:103], v[156:171]
    v_exp_f32 v91, v91
    buffer_load_dwordx4 v[120:123], v2, s[16:19], s28 offen sc1
    v_exp_f32 v92, v92
    v_exp_f32 v93, v93
    v_cvt_pk_bf16_f32 v109, v90, v91
    v_exp_f32 v94, v94
    v_exp_f32 v95, v95
    v_cvt_pk_bf16_f32 v110, v92, v93
    v_cvt_pk_bf16_f32 v111, v94, v95
    v_mfma_f32_32x32x16_bf16 v[80:95], v[112:115], v[28:31], 0
    v_exp_f32 v64, v64
    v_exp_f32 v65, v65
    v_exp_f32 v66, v66
    v_mfma_f32_32x32x8_bf16 v[80:95], v[124:125], v[54:55], v[80:95]
    v_exp_f32 v67, v67
    v_exp_f32 v68, v68
    v_cvt_pk_bf16_f32 v96, v64, v65
    v_exp_f32 v69, v69
    v_exp_f32 v70, v70
    v_cvt_pk_bf16_f32 v97, v66, v67
    v_exp_f32 v71, v71
    v_cvt_pk_bf16_f32 v98, v68, v69
    v_exp_f32 v72, v72
    v_mfma_f32_32x32x16_bf16 v[168:183], v[130:133], v[104:107], v[168:183]
    v_exp_f32 v73, v73
    v_exp_f32 v74, v74
    v_cvt_pk_bf16_f32 v99, v70, v71
    v_cvt_pk_bf16_f32 v100, v72, v73
    v_mfma_f32_32x32x16_bf16 v[168:183], v[134:137], v[108:111], v[168:183]
    v_exp_f32 v75, v75
    buffer_load_dwordx2 v[128:129], v9, s[16:19], s28 offen offset:1024 sc1
    v_exp_f32 v76, v76
    v_exp_f32 v77, v77
    v_cvt_pk_bf16_f32 v101, v74, v75
    v_exp_f32 v78, v78
    v_exp_f32 v79, v79
    v_cvt_pk_bf16_f32 v102, v76, v77
    v_cvt_pk_bf16_f32 v103, v78, v79
    v_mfma_f32_32x32x16_bf16 v[64:79], v[112:115], v[32:35], 0
    v_exp_f32 v80, v80
    v_exp_f32 v81, v81
    v_exp_f32 v82, v82
    v_mfma_f32_32x32x8_bf16 v[64:79], v[124:125], v[56:57], v[64:79]
    v_exp_f32 v83, v83
    v_exp_f32 v84, v84
    v_cvt_pk_bf16_f32 v104, v80, v81
    v_exp_f32 v85, v85
    v_exp_f32 v86, v86
    v_cvt_pk_bf16_f32 v105, v82, v83
    v_exp_f32 v87, v87
    v_cvt_pk_bf16_f32 v106, v84, v85
    v_exp_f32 v88, v88
    v_mfma_f32_32x32x16_bf16 v[180:195], v[130:133], v[96:99], v[180:195]
    v_exp_f32 v89, v89
    v_exp_f32 v90, v90
    v_cvt_pk_bf16_f32 v107, v86, v87
    v_cvt_pk_bf16_f32 v108, v88, v89
    v_mfma_f32_32x32x16_bf16 v[180:195], v[134:137], v[100:103], v[180:195]
    v_exp_f32 v91, v91
    buffer_load_dwordx4 v[146:149], v11, s[16:19], s28 offen offset:1536 sc1
    v_exp_f32 v92, v92
    v_exp_f32 v93, v93
    v_cvt_pk_bf16_f32 v109, v90, v91
    v_exp_f32 v94, v94
    v_exp_f32 v95, v95
    v_cvt_pk_bf16_f32 v110, v92, v93
    v_cvt_pk_bf16_f32 v111, v94, v95
    v_mfma_f32_32x32x16_bf16 v[80:95], v[112:115], v[36:39], 0
    v_exp_f32 v64, v64
    v_exp_f32 v65, v65
    v_exp_f32 v66, v66
    v_mfma_f32_32x32x8_bf16 v[80:95], v[124:125], v[58:59], v[80:95]
    v_exp_f32 v67, v67
    v_exp_f32 v68, v68
    v_cvt_pk_bf16_f32 v96, v64, v65
    v_exp_f32 v69, v69
    v_exp_f32 v70, v70
    v_cvt_pk_bf16_f32 v97, v66, v67
    v_exp_f32 v71, v71
    v_cvt_pk_bf16_f32 v98, v68, v69
    v_exp_f32 v72, v72
    v_mfma_f32_32x32x16_bf16 v[192:207], v[130:133], v[104:107], v[192:207]
    v_exp_f32 v73, v73
    v_exp_f32 v74, v74
    v_cvt_pk_bf16_f32 v99, v70, v71
    v_cvt_pk_bf16_f32 v100, v72, v73
    v_mfma_f32_32x32x16_bf16 v[192:207], v[134:137], v[108:111], v[192:207]
    v_exp_f32 v75, v75
    buffer_load_dwordx4 v[150:153], v11, s[16:19], s28 offen offset:2304 sc1
    v_exp_f32 v76, v76
    v_exp_f32 v77, v77
    v_cvt_pk_bf16_f32 v101, v74, v75
    v_exp_f32 v78, v78
    v_exp_f32 v79, v79
    v_cvt_pk_bf16_f32 v102, v76, v77
    v_cvt_pk_bf16_f32 v103, v78, v79
    v_mfma_f32_32x32x16_bf16 v[64:79], v[112:115], v[40:43], 0
    v_exp_f32 v80, v80
    v_exp_f32 v81, v81
    v_exp_f32 v82, v82
    v_mfma_f32_32x32x8_bf16 v[64:79], v[124:125], v[60:61], v[64:79]
    v_exp_f32 v83, v83
    v_exp_f32 v84, v84
    v_cvt_pk_bf16_f32 v104, v80, v81
    v_exp_f32 v85, v85
    v_exp_f32 v86, v86
    v_cvt_pk_bf16_f32 v105, v82, v83
    v_exp_f32 v87, v87
    v_cvt_pk_bf16_f32 v106, v84, v85
    v_exp_f32 v88, v88
    v_mfma_f32_32x32x16_bf16 v[204:219], v[130:133], v[96:99], v[204:219]
    v_exp_f32 v89, v89
    v_exp_f32 v90, v90
    v_cvt_pk_bf16_f32 v107, v86, v87
    v_cvt_pk_bf16_f32 v108, v88, v89
    v_mfma_f32_32x32x16_bf16 v[204:219], v[134:137], v[100:103], v[204:219]
    v_exp_f32 v91, v91
    s_add_u32 s28, s28, 12288
    s_sub_u32 s27, s28, 196608
    v_exp_f32 v92, v92
    s_cmp_ge_u32 s28, 196608
    s_cselect_b32 s28, s27, s28
    v_exp_f32 v93, v93
    v_cvt_pk_bf16_f32 v109, v90, v91
    v_exp_f32 v94, v94
    v_exp_f32 v95, v95
    v_cvt_pk_bf16_f32 v110, v92, v93
    v_cvt_pk_bf16_f32 v111, v94, v95
    v_mfma_f32_32x32x16_bf16 v[80:95], v[112:115], v[44:47], 0
    v_exp_f32 v64, v64
    v_exp_f32 v65, v65
    v_exp_f32 v66, v66
    v_mfma_f32_32x32x8_bf16 v[80:95], v[124:125], v[62:63], v[80:95]
    v_exp_f32 v67, v67
    v_exp_f32 v68, v68
    v_cvt_pk_bf16_f32 v96, v64, v65
    v_exp_f32 v69, v69
    v_exp_f32 v70, v70
    v_cvt_pk_bf16_f32 v97, v66, v67
    v_exp_f32 v71, v71
    v_cvt_pk_bf16_f32 v98, v68, v69
    v_exp_f32 v72, v72
    v_mfma_f32_32x32x16_bf16 v[216:231], v[130:133], v[104:107], v[216:231]
    v_exp_f32 v73, v73
    v_exp_f32 v74, v74
    v_cvt_pk_bf16_f32 v99, v70, v71
    v_cvt_pk_bf16_f32 v100, v72, v73
    v_mfma_f32_32x32x16_bf16 v[216:231], v[134:137], v[108:111], v[216:231]
    v_exp_f32 v75, v75
    s_cmp_eq_u32 s34, 0
    s_cbranch_scc1 L_cw_98
L_cr_99:
    v_exp_f32 v76, v76
    s_cmp_eq_u32 s34, 1
    s_cbranch_scc1 L_cw_100
L_cr_101:
    v_exp_f32 v77, v77
    v_cvt_pk_bf16_f32 v101, v74, v75
    v_exp_f32 v78, v78
    v_exp_f32 v79, v79
    v_cvt_pk_bf16_f32 v102, v76, v77
    v_cvt_pk_bf16_f32 v103, v78, v79
    s_waitcnt vmcnt(6)
    v_mfma_f32_32x32x16_bf16 v[64:79], v[116:119], v[16:19], 0
    v_exp_f32 v80, v80
    v_exp_f32 v81, v81
    v_exp_f32 v82, v82
    v_mfma_f32_32x32x8_bf16 v[64:79], v[126:127], v[48:49], v[64:79]
    v_exp_f32 v83, v83
    v_exp_f32 v84, v84
    v_cvt_pk_bf16_f32 v104, v80, v81
    v_exp_f32 v85, v85
    v_exp_f32 v86, v86
    v_cvt_pk_bf16_f32 v105, v82, v83
    v_exp_f32 v87, v87
    v_cvt_pk_bf16_f32 v106, v84, v85
    v_exp_f32 v88, v88
    v_mfma_f32_32x32x16_bf16 v[228:243], v[130:133], v[96:99], v[228:243]
    v_exp_f32 v89, v89
    v_exp_f32 v90, v90
    v_cvt_pk_bf16_f32 v107, v86, v87
    v_cvt_pk_bf16_f32 v108, v88, v89
    v_mfma_f32_32x32x16_bf16 v[228:243], v[134:137], v[100:103], v[228:243]
    v_exp_f32 v91, v91
    v_exp_f32 v92, v92
    v_exp_f32 v93, v93
    v_cvt_pk_bf16_f32 v109, v90, v91
    v_exp_f32 v94, v94
    v_exp_f32 v95, v95
    v_cvt_pk_bf16_f32 v110, v92, v93
    v_cvt_pk_bf16_f32 v111, v94, v95
    v_mfma_f32_32x32x16_bf16 v[80:95], v[116:119], v[20:23], 0
    v_exp_f32 v64, v64
    v_exp_f32 v65, v65
    v_exp_f32 v66, v66
    v_mfma_f32_32x32x8_bf16 v[80:95], v[126:127], v[50:51], v[80:95]
    v_exp_f32 v67, v67
    v_exp_f32 v68, v68
    v_cvt_pk_bf16_f32 v96, v64, v65
    v_exp_f32 v69, v69
    v_exp_f32 v70, v70
    v_cvt_pk_bf16_f32 v97, v66, v67
    v_exp_f32 v71, v71
    v_cvt_pk_bf16_f32 v98, v68, v69
    v_exp_f32 v72, v72
    v_mfma_f32_32x32x16_bf16 v[240:255], v[130:133], v[104:107], v[240:255]
    v_exp_f32 v73, v73
    v_exp_f32 v74, v74
    v_cvt_pk_bf16_f32 v99, v70, v71
    v_cvt_pk_bf16_f32 v100, v72, v73
    v_mfma_f32_32x32x16_bf16 v[240:255], v[134:137], v[108:111], v[240:255]
    v_exp_f32 v75, v75
    v_exp_f32 v76, v76
    v_exp_f32 v77, v77
    v_cvt_pk_bf16_f32 v101, v74, v75
    v_exp_f32 v78, v78
    v_exp_f32 v79, v79
    v_cvt_pk_bf16_f32 v102, v76, v77
    v_cvt_pk_bf16_f32 v103, v78, v79
    s_waitcnt vmcnt(4)
    v_mfma_f32_32x32x16_bf16 v[64:79], v[116:119], v[24:27], 0
    v_exp_f32 v80, v80
    v_exp_f32 v81, v81
    v_exp_f32 v82, v82
    v_mfma_f32_32x32x8_bf16 v[64:79], v[126:127], v[52:53], v[64:79]
    v_exp_f32 v83, v83
    v_exp_f32 v84, v84
    v_cvt_pk_bf16_f32 v104, v80, v81
    v_exp_f32 v85, v85
    v_exp_f32 v86, v86
    v_cvt_pk_bf16_f32 v105, v82, v83
    v_exp_f32 v87, v87
    v_cvt_pk_bf16_f32 v106, v84, v85
    v_exp_f32 v88, v88
    v_mfma_f32_32x32x16_bf16 v[156:171], v[138:141], v[96:99], v[156:171]
    v_exp_f32 v89, v89
    v_exp_f32 v90, v90
    v_cvt_pk_bf16_f32 v107, v86, v87
    v_cvt_pk_bf16_f32 v108, v88, v89
    v_mfma_f32_32x32x16_bf16 v[156:171], v[142:145], v[100:103], v[156:171]
    v_exp_f32 v91, v91
    buffer_load_dwordx4 v[112:115], v2, s[16:19], s28 offen sc1
    v_exp_f32 v92, v92
    v_exp_f32 v93, v93
    v_cvt_pk_bf16_f32 v109, v90, v91
    v_exp_f32 v94, v94
    v_exp_f32 v95, v95
    v_cvt_pk_bf16_f32 v110, v92, v93
    v_cvt_pk_bf16_f32 v111, v94, v95
    v_mfma_f32_32x32x16_bf16 v[80:95], v[116:119], v[28:31], 0
    v_exp_f32 v64, v64
    v_exp_f32 v65, v65
    v_exp_f32 v66, v66
    v_mfma_f32_32x32x8_bf16 v[80:95], v[126:127], v[54:55], v[80:95]
    v_exp_f32 v67, v67
    v_exp_f32 v68, v68
    v_cvt_pk_bf16_f32 v96, v64, v65
    v_exp_f32 v69, v69
    v_exp_f32 v70, v70
    v_cvt_pk_bf16_f32 v97, v66, v67
    v_exp_f32 v71, v71
    v_cvt_pk_bf16_f32 v98, v68, v69
    v_exp_f32 v72, v72
    v_mfma_f32_32x32x16_bf16 v[168:183], v[138:141], v[104:107], v[168:183]
    v_exp_f32 v73, v73
    v_exp_f32 v74, v74
    v_cvt_pk_bf16_f32 v99, v70, v71
    v_cvt_pk_bf16_f32 v100, v72, v73
    v_mfma_f32_32x32x16_bf16 v[168:183], v[142:145], v[108:111], v[168:183]
    v_exp_f32 v75, v75
    buffer_load_dwordx2 v[124:125], v9, s[16:19], s28 offen offset:1024 sc1
    v_exp_f32 v76, v76
    v_exp_f32 v77, v77
    v_cvt_pk_bf16_f32 v101, v74, v75
    v_exp_f32 v78, v78
    v_exp_f32 v79, v79
    v_cvt_pk_bf16_f32 v102, v76, v77
    v_cvt_pk_bf16_f32 v103, v78, v79
    v_mfma_f32_32x32x16_bf16 v[64:79], v[116:119], v[32:35], 0
    v_exp_f32 v80, v80
    v_exp_f32 v81, v81
    v_exp_f32 v82, v82
    v_mfma_f32_32x32x8_bf16 v[64:79], v[126:127], v[56:57], v[64:79]
    v_exp_f32 v83, v83
    v_exp_f32 v84, v84
    v_cvt_pk_bf16_f32 v104, v80, v81
    v_exp_f32 v85, v85
    v_exp_f32 v86, v86
    v_cvt_pk_bf16_f32 v105, v82, v83
    v_exp_f32 v87, v87
    v_cvt_pk_bf16_f32 v106, v84, v85
    v_exp_f32 v88, v88
    v_mfma_f32_32x32x16_bf16 v[180:195], v[138:141], v[96:99], v[180:195]
    v_exp_f32 v89, v89
    v_exp_f32 v90, v90
    v_cvt_pk_bf16_f32 v107, v86, v87
    v_cvt_pk_bf16_f32 v108, v88, v89
    v_mfma_f32_32x32x16_bf16 v[180:195], v[142:145], v[100:103], v[180:195]
    v_exp_f32 v91, v91
    buffer_load_dwordx4 v[130:133], v11, s[16:19], s28 offen offset:1536 sc1
    v_exp_f32 v92, v92
    v_exp_f32 v93, v93
    v_cvt_pk_bf16_f32 v109, v90, v91
    v_exp_f32 v94, v94
    v_exp_f32 v95, v95
    v_cvt_pk_bf16_f32 v110, v92, v93
    v_cvt_pk_bf16_f32 v111, v94, v95
    v_mfma_f32_32x32x16_bf16 v[80:95], v[116:119], v[36:39], 0
    v_exp_f32 v64, v64
    v_exp_f32 v65, v65
    v_exp_f32 v66, v66
    v_mfma_f32_32x32x8_bf16 v[80:95], v[126:127], v[58:59], v[80:95]
    v_exp_f32 v67, v67
    v_exp_f32 v68, v68
    v_cvt_pk_bf16_f32 v96, v64, v65
    v_exp_f32 v69, v69
    v_exp_f32 v70, v70
    v_cvt_pk_bf16_f32 v97, v66, v67
    v_exp_f32 v71, v71
    v_cvt_pk_bf16_f32 v98, v68, v69
    v_exp_f32 v72, v72
    v_mfma_f32_32x32x16_bf16 v[192:207], v[138:141], v[104:107], v[192:207]
    v_exp_f32 v73, v73
    v_exp_f32 v74, v74
    v_cvt_pk_bf16_f32 v99, v70, v71
    v_cvt_pk_bf16_f32 v100, v72, v73
    v_mfma_f32_32x32x16_bf16 v[192:207], v[142:145], v[108:111], v[192:207]
    v_exp_f32 v75, v75
    buffer_load_dwordx4 v[134:137], v11, s[16:19], s28 offen offset:2304 sc1
    v_exp_f32 v76, v76
    v_exp_f32 v77, v77
    v_cvt_pk_bf16_f32 v101, v74, v75
    v_exp_f32 v78, v78
    v_exp_f32 v79, v79
    v_cvt_pk_bf16_f32 v102, v76, v77
    v_cvt_pk_bf16_f32 v103, v78, v79
    v_mfma_f32_32x32x16_bf16 v[64:79], v[116:119], v[40:43], 0
    v_exp_f32 v80, v80
    v_exp_f32 v81, v81
    v_exp_f32 v82, v82
    v_mfma_f32_32x32x8_bf16 v[64:79], v[126:127], v[60:61], v[64:79]
    v_exp_f32 v83, v83
    v_exp_f32 v84, v84
    v_cvt_pk_bf16_f32 v104, v80, v81
    v_exp_f32 v85, v85
    v_exp_f32 v86, v86
    v_cvt_pk_bf16_f32 v105, v82, v83
    v_exp_f32 v87, v87
    v_cvt_pk_bf16_f32 v106, v84, v85
    v_exp_f32 v88, v88
    v_mfma_f32_32x32x16_bf16 v[204:219], v[138:141], v[96:99], v[204:219]
    v_exp_f32 v89, v89
    v_exp_f32 v90, v90
    v_cvt_pk_bf16_f32 v107, v86, v87
    v_cvt_pk_bf16_f32 v108, v88, v89
    v_mfma_f32_32x32x16_bf16 v[204:219], v[142:145], v[100:103], v[204:219]
    v_exp_f32 v91, v91
    s_add_u32 s28, s28, 12288
    s_sub_u32 s27, s28, 196608
    v_exp_f32 v92, v92
    s_cmp_ge_u32 s28, 196608
    s_cselect_b32 s28, s27, s28
    v_exp_f32 v93, v93
    v_cvt_pk_bf16_f32 v109, v90, v91
    v_exp_f32 v94, v94
    v_exp_f32 v95, v95
    v_cvt_pk_bf16_f32 v110, v92, v93
    v_cvt_pk_bf16_f32 v111, v94, v95
    v_mfma_f32_32x32x16_bf16 v[80:95], v[116:119], v[44:47], 0
    v_exp_f32 v64, v64
    v_exp_f32 v65, v65
    v_exp_f32 v66, v66
    v_mfma_f32_32x32x8_bf16 v[80:95], v[126:127], v[62:63], v[80:95]
    v_exp_f32 v67, v67
    v_exp_f32 v68, v68
    v_cvt_pk_bf16_f32 v96, v64, v65
    v_exp_f32 v69, v69
    v_exp_f32 v70, v70
    v_cvt_pk_bf16_f32 v97, v66, v67
    v_exp_f32 v71, v71
    v_cvt_pk_bf16_f32 v98, v68, v69
    v_exp_f32 v72, v72
    v_mfma_f32_32x32x16_bf16 v[216:231], v[138:141], v[104:107], v[216:231]
    v_exp_f32 v73, v73
    v_exp_f32 v74, v74
    v_cvt_pk_bf16_f32 v99, v70, v71
    v_cvt_pk_bf16_f32 v100, v72, v73
    v_mfma_f32_32x32x16_bf16 v[216:231], v[142:145], v[108:111], v[216:231]
    v_exp_f32 v75, v75
    s_cmp_eq_u32 s34, 0
    s_cbranch_scc1 L_cw_102
L_cr_103:
    v_exp_f32 v76, v76
    s_cmp_eq_u32 s34, 1
    s_cbranch_scc1 L_cw_104
L_cr_105:
    v_exp_f32 v77, v77
    v_cvt_pk_bf16_f32 v101, v74, v75
    v_exp_f32 v78, v78
    v_exp_f32 v79, v79
    v_cvt_pk_bf16_f32 v102, v76, v77
    v_cvt_pk_bf16_f32 v103, v78, v79
    s_waitcnt vmcnt(6)
    v_mfma_f32_32x32x16_bf16 v[64:79], v[120:123], v[16:19], 0
    v_exp_f32 v80, v80
    v_exp_f32 v81, v81
    v_exp_f32 v82, v82
    v_mfma_f32_32x32x8_bf16 v[64:79], v[128:129], v[48:49], v[64:79]
    v_exp_f32 v83, v83
    v_exp_f32 v84, v84
    v_cvt_pk_bf16_f32 v104, v80, v81
    v_exp_f32 v85, v85
    v_exp_f32 v86, v86
    v_cvt_pk_bf16_f32 v105, v82, v83
    v_exp_f32 v87, v87
    v_cvt_pk_bf16_f32 v106, v84, v85
    v_exp_f32 v88, v88
    v_mfma_f32_32x32x16_bf16 v[228:243], v[138:141], v[96:99], v[228:243]
    v_exp_f32 v89, v89
    v_exp_f32 v90, v90
    v_cvt_pk_bf16_f32 v107, v86, v87
    v_cvt_pk_bf16_f32 v108, v88, v89
    v_mfma_f32_32x32x16_bf16 v[228:243], v[142:145], v[100:103], v[228:243]
    v_exp_f32 v91, v91
    v_exp_f32 v92, v92
    v_exp_f32 v93, v93
    v_cvt_pk_bf16_f32 v109, v90, v91
    v_exp_f32 v94, v94
    v_exp_f32 v95, v95
    v_cvt_pk_bf16_f32 v110, v92, v93
    v_cvt_pk_bf16_f32 v111, v94, v95
    v_mfma_f32_32x32x16_bf16 v[80:95], v[120:123], v[20:23], 0
    v_exp_f32 v64, v64
    v_exp_f32 v65, v65
    v_exp_f32 v66, v66
    v_mfma_f32_32x32x8_bf16 v[80:95], v[128:129], v[50:51], v[80:95]
    v_exp_f32 v67, v67
    v_exp_f32 v68, v68
    v_cvt_pk_bf16_f32 v96, v64, v65
    v_exp_f32 v69, v69
    v_exp_f32 v70, v70
    v_cvt_pk_bf16_f32 v97, v66, v67
    v_exp_f32 v71, v71
    v_cvt_pk_bf16_f32 v98, v68, v69
    v_exp_f32 v72, v72
    v_mfma_f32_32x32x16_bf16 v[240:255], v[138:141], v[104:107], v[240:255]
    v_exp_f32 v73, v73
    v_exp_f32 v74, v74
    v_cvt_pk_bf16_f32 v99, v70, v71
    v_cvt_pk_bf16_f32 v100, v72, v73
    v_mfma_f32_32x32x16_bf16 v[240:255], v[142:145], v[108:111], v[240:255]
    v_exp_f32 v75, v75
    v_exp_f32 v76, v76
    v_exp_f32 v77, v77
    v_cvt_pk_bf16_f32 v101, v74, v75
    v_exp_f32 v78, v78
    v_exp_f32 v79, v79
    v_cvt_pk_bf16_f32 v102, v76, v77
    v_cvt_pk_bf16_f32 v103, v78, v79
    s_waitcnt vmcnt(4)
    v_mfma_f32_32x32x16_bf16 v[64:79], v[120:123], v[24:27], 0
    v_exp_f32 v80, v80
    v_exp_f32 v81, v81
    v_exp_f32 v82, v82
    v_mfma_f32_32x32x8_bf16 v[64:79], v[128:129], v[52:53], v[64:79]
    v_exp_f32 v83, v83
    v_exp_f32 v84, v84
    v_cvt_pk_bf16_f32 v104, v80, v81
    v_exp_f32 v85, v85
    v_exp_f32 v86, v86
    v_cvt_pk_bf16_f32 v105, v82, v83
    v_exp_f32 v87, v87
    v_cvt_pk_bf16_f32 v106, v84, v85
    v_exp_f32 v88, v88
    v_mfma_f32_32x32x16_bf16 v[156:171], v[146:149], v[96:99], v[156:171]
    v_exp_f32 v89, v89
    v_exp_f32 v90, v90
    v_cvt_pk_bf16_f32 v107, v86, v87
    v_cvt_pk_bf16_f32 v108, v88, v89
    v_mfma_f32_32x32x16_bf16 v[156:171], v[150:153], v[100:103], v[156:171]
    v_exp_f32 v91, v91
    buffer_load_dwordx4 v[116:119], v2, s[16:19], s28 offen sc1
    v_exp_f32 v92, v92
    v_exp_f32 v93, v93
    v_cvt_pk_bf16_f32 v109, v90, v91
    v_exp_f32 v94, v94
    v_exp_f32 v95, v95
    v_cvt_pk_bf16_f32 v110, v92, v93
    v_cvt_pk_bf16_f32 v111, v94, v95
    v_mfma_f32_32x32x16_bf16 v[80:95], v[120:123], v[28:31], 0
    v_exp_f32 v64, v64
    v_exp_f32 v65, v65
    v_exp_f32 v66, v66
    v_mfma_f32_32x32x8_bf16 v[80:95], v[128:129], v[54:55], v[80:95]
    v_exp_f32 v67, v67
    v_exp_f32 v68, v68
    v_cvt_pk_bf16_f32 v96, v64, v65
    v_exp_f32 v69, v69
    v_exp_f32 v70, v70
    v_cvt_pk_bf16_f32 v97, v66, v67
    v_exp_f32 v71, v71
    v_cvt_pk_bf16_f32 v98, v68, v69
    v_exp_f32 v72, v72
    v_mfma_f32_32x32x16_bf16 v[168:183], v[146:149], v[104:107], v[168:183]
    v_exp_f32 v73, v73
    v_exp_f32 v74, v74
    v_cvt_pk_bf16_f32 v99, v70, v71
    v_cvt_pk_bf16_f32 v100, v72, v73
    v_mfma_f32_32x32x16_bf16 v[168:183], v[150:153], v[108:111], v[168:183]
    v_exp_f32 v75, v75
    buffer_load_dwordx2 v[126:127], v9, s[16:19], s28 offen offset:1024 sc1
    v_exp_f32 v76, v76
    v_exp_f32 v77, v77
    v_cvt_pk_bf16_f32 v101, v74, v75
    v_exp_f32 v78, v78
    v_exp_f32 v79, v79
    v_cvt_pk_bf16_f32 v102, v76, v77
    v_cvt_pk_bf16_f32 v103, v78, v79
    v_mfma_f32_32x32x16_bf16 v[64:79], v[120:123], v[32:35], 0
    v_exp_f32 v80, v80
    v_exp_f32 v81, v81
    v_exp_f32 v82, v82
    v_mfma_f32_32x32x8_bf16 v[64:79], v[128:129], v[56:57], v[64:79]
    v_exp_f32 v83, v83
    v_exp_f32 v84, v84
    v_cvt_pk_bf16_f32 v104, v80, v81
    v_exp_f32 v85, v85
    v_exp_f32 v86, v86
    v_cvt_pk_bf16_f32 v105, v82, v83
    v_exp_f32 v87, v87
    v_cvt_pk_bf16_f32 v106, v84, v85
    v_exp_f32 v88, v88
    v_mfma_f32_32x32x16_bf16 v[180:195], v[146:149], v[96:99], v[180:195]
    v_exp_f32 v89, v89
    v_exp_f32 v90, v90
    v_cvt_pk_bf16_f32 v107, v86, v87
    v_cvt_pk_bf16_f32 v108, v88, v89
    v_mfma_f32_32x32x16_bf16 v[180:195], v[150:153], v[100:103], v[180:195]
    v_exp_f32 v91, v91
    buffer_load_dwordx4 v[138:141], v11, s[16:19], s28 offen offset:1536 sc1
    v_exp_f32 v92, v92
    v_exp_f32 v93, v93
    v_cvt_pk_bf16_f32 v109, v90, v91
    v_exp_f32 v94, v94
    v_exp_f32 v95, v95
    v_cvt_pk_bf16_f32 v110, v92, v93
    v_cvt_pk_bf16_f32 v111, v94, v95
    v_mfma_f32_32x32x16_bf16 v[80:95], v[120:123], v[36:39], 0
    v_exp_f32 v64, v64
    v_exp_f32 v65, v65
    v_exp_f32 v66, v66
    v_mfma_f32_32x32x8_bf16 v[80:95], v[128:129], v[58:59], v[80:95]
    v_exp_f32 v67, v67
    v_exp_f32 v68, v68
    v_cvt_pk_bf16_f32 v96, v64, v65
    v_exp_f32 v69, v69
    v_exp_f32 v70, v70
    v_cvt_pk_bf16_f32 v97, v66, v67
    v_exp_f32 v71, v71
    v_cvt_pk_bf16_f32 v98, v68, v69
    v_exp_f32 v72, v72
    v_mfma_f32_32x32x16_bf16 v[192:207], v[146:149], v[104:107], v[192:207]
    v_exp_f32 v73, v73
    v_exp_f32 v74, v74
    v_cvt_pk_bf16_f32 v99, v70, v71
    v_cvt_pk_bf16_f32 v100, v72, v73
    v_mfma_f32_32x32x16_bf16 v[192:207], v[150:153], v[108:111], v[192:207]
    v_exp_f32 v75, v75
    buffer_load_dwordx4 v[142:145], v11, s[16:19], s28 offen offset:2304 sc1
    v_exp_f32 v76, v76
    v_exp_f32 v77, v77
    v_cvt_pk_bf16_f32 v101, v74, v75
    v_exp_f32 v78, v78
    v_exp_f32 v79, v79
    v_cvt_pk_bf16_f32 v102, v76, v77
    v_cvt_pk_bf16_f32 v103, v78, v79
    v_mfma_f32_32x32x16_bf16 v[64:79], v[120:123], v[40:43], 0
    v_exp_f32 v80, v80
    v_exp_f32 v81, v81
    v_exp_f32 v82, v82
    v_mfma_f32_32x32x8_bf16 v[64:79], v[128:129], v[60:61], v[64:79]
    v_exp_f32 v83, v83
    v_exp_f32 v84, v84
    v_cvt_pk_bf16_f32 v104, v80, v81
    v_exp_f32 v85, v85
    v_exp_f32 v86, v86
    v_cvt_pk_bf16_f32 v105, v82, v83
    v_exp_f32 v87, v87
    v_cvt_pk_bf16_f32 v106, v84, v85
    v_exp_f32 v88, v88
    v_mfma_f32_32x32x16_bf16 v[204:219], v[146:149], v[96:99], v[204:219]
    v_exp_f32 v89, v89
    v_exp_f32 v90, v90
    v_cvt_pk_bf16_f32 v107, v86, v87
    v_cvt_pk_bf16_f32 v108, v88, v89
    v_mfma_f32_32x32x16_bf16 v[204:219], v[150:153], v[100:103], v[204:219]
    v_exp_f32 v91, v91
    s_add_u32 s28, s28, 12288
    s_sub_u32 s27, s28, 196608
    v_exp_f32 v92, v92
    s_cmp_ge_u32 s28, 196608
    s_cselect_b32 s28, s27, s28
    v_exp_f32 v93, v93
    v_cvt_pk_bf16_f32 v109, v90, v91
    v_exp_f32 v94, v94
    v_exp_f32 v95, v95
    v_cvt_pk_bf16_f32 v110, v92, v93
    v_cvt_pk_bf16_f32 v111, v94, v95
    v_mfma_f32_32x32x16_bf16 v[80:95], v[120:123], v[44:47], 0
    v_exp_f32 v64, v64
    v_exp_f32 v65, v65
    v_exp_f32 v66, v66
    v_mfma_f32_32x32x8_bf16 v[80:95], v[128:129], v[62:63], v[80:95]
    v_exp_f32 v67, v67
    v_exp_f32 v68, v68
    v_cvt_pk_bf16_f32 v96, v64, v65
    v_exp_f32 v69, v69
    v_exp_f32 v70, v70
    v_cvt_pk_bf16_f32 v97, v66, v67
    v_exp_f32 v71, v71
    v_cvt_pk_bf16_f32 v98, v68, v69
    v_exp_f32 v72, v72
    v_mfma_f32_32x32x16_bf16 v[216:231], v[146:149], v[104:107], v[216:231]
    v_exp_f32 v73, v73
    v_exp_f32 v74, v74
    v_cvt_pk_bf16_f32 v99, v70, v71
    v_cvt_pk_bf16_f32 v100, v72, v73
    v_mfma_f32_32x32x16_bf16 v[216:231], v[150:153], v[108:111], v[216:231]
    v_exp_f32 v75, v75
    s_cmp_eq_u32 s34, 0
    s_cbranch_scc1 L_cw_106
L_cr_107:
    v_exp_f32 v76, v76
    s_cmp_eq_u32 s34, 1
    s_cbranch_scc1 L_cw_108
L_cr_109:
    v_exp_f32 v77, v77
    v_cvt_pk_bf16_f32 v101, v74, v75
    v_exp_f32 v78, v78
    v_exp_f32 v79, v79
    v_cvt_pk_bf16_f32 v102, v76, v77
    v_cvt_pk_bf16_f32 v103, v78, v79
    s_waitcnt vmcnt(6)
    v_mfma_f32_32x32x16_bf16 v[64:79], v[112:115], v[16:19], 0
    v_exp_f32 v80, v80
    v_exp_f32 v81, v81
    v_exp_f32 v82, v82
    v_mfma_f32_32x32x8_bf16 v[64:79], v[124:125], v[48:49], v[64:79]
    v_exp_f32 v83, v83
    v_exp_f32 v84, v84
    v_cvt_pk_bf16_f32 v104, v80, v81
    v_exp_f32 v85, v85
    v_exp_f32 v86, v86
    v_cvt_pk_bf16_f32 v105, v82, v83
    v_exp_f32 v87, v87
    v_cvt_pk_bf16_f32 v106, v84, v85
    v_exp_f32 v88, v88
    v_mfma_f32_32x32x16_bf16 v[228:243], v[146:149], v[96:99], v[228:243]
    v_exp_f32 v89, v89
    v_exp_f32 v90, v90
    v_cvt_pk_bf16_f32 v107, v86, v87
    v_cvt_pk_bf16_f32 v108, v88, v89
    v_mfma_f32_32x32x16_bf16 v[228:243], v[150:153], v[100:103], v[228:243]
    v_exp_f32 v91, v91
    v_exp_f32 v92, v92
    v_exp_f32 v93, v93
    v_cvt_pk_bf16_f32 v109, v90, v91
    v_exp_f32 v94, v94
    v_exp_f32 v95, v95
    v_cvt_pk_bf16_f32 v110, v92, v93
    v_cvt_pk_bf16_f32 v111, v94, v95
    s_add_u32 s34, s34, 1
    s_cmp_lt_u32 s34, 5
    s_cbranch_scc1 L_a_loop
    v_mfma_f32_32x32x16_bf16 v[80:95], v[112:115], v[20:23], 0
    v_exp_f32 v64, v64
    v_exp_f32 v65, v65
    v_exp_f32 v66, v66
    v_mfma_f32_32x32x8_bf16 v[80:95], v[124:125], v[50:51], v[80:95]
    v_exp_f32 v67, v67
    v_exp_f32 v68, v68
    v_cvt_pk_bf16_f32 v96, v64, v65
    v_exp_f32 v69, v69
    v_exp_f32 v70, v70
    v_cvt_pk_bf16_f32 v97, v66, v67
    v_exp_f32 v71, v71
    v_cvt_pk_bf16_f32 v98, v68, v69
    v_exp_f32 v72, v72
    v_mfma_f32_32x32x16_bf16 v[240:255], v[146:149], v[104:107], v[240:255]
    v_exp_f32 v73, v73
    v_exp_f32 v74, v74
    v_cvt_pk_bf16_f32 v99, v70, v71
    v_cvt_pk_bf16_f32 v100, v72, v73
    v_mfma_f32_32x32x16_bf16 v[240:255], v[150:153], v[108:111], v[240:255]
    v_exp_f32 v75, v75
    ds_read_b32 v8, v12
    v_exp_f32 v76, v76
    v_exp_f32 v77, v77
    v_cvt_pk_bf16_f32 v101, v74, v75
    v_exp_f32 v78, v78
    v_exp_f32 v79, v79
    v_cvt_pk_bf16_f32 v102, v76, v77
    v_cvt_pk_bf16_f32 v103, v78, v79
    s_waitcnt vmcnt(4)
    v_mfma_f32_32x32x16_bf16 v[64:79], v[112:115], v[24:27], 0
    v_exp_f32 v80, v80
    v_exp_f32 v81, v81
    v_exp_f32 v82, v82
    v_mfma_f32_32x32x8_bf16 v[64:79], v[124:125], v[52:53], v[64:79]
    v_exp_f32 v83, v83
    v_exp_f32 v84, v84
    v_cvt_pk_bf16_f32 v104, v80, v81
    v_exp_f32 v85, v85
    v_exp_f32 v86, v86
    v_cvt_pk_bf16_f32 v105, v82, v83
    v_exp_f32 v87, v87
    v_cvt_pk_bf16_f32 v106, v84, v85
    v_exp_f32 v88, v88
    v_mfma_f32_32x32x16_bf16 v[156:171], v[130:133], v[96:99], v[156:171]
    v_exp_f32 v89, v89
    v_exp_f32 v90, v90
    v_cvt_pk_bf16_f32 v107, v86, v87
    v_cvt_pk_bf16_f32 v108, v88, v89
    v_mfma_f32_32x32x16_bf16 v[156:171], v[134:137], v[100:103], v[156:171]
    v_exp_f32 v91, v91
    s_waitcnt lgkmcnt(0)
    v_cmp_gt_u32 vcc, 5, v8
    s_cmp_eq_u64 vcc, 0
    s_cbranch_scc0 L_psl_112
L_pok_110:
    v_exp_f32 v92, v92
    v_exp_f32 v93, v93
    v_cvt_pk_bf16_f32 v109, v90, v91
    v_exp_f32 v94, v94
    v_exp_f32 v95, v95
    v_cvt_pk_bf16_f32 v110, v92, v93
    v_cvt_pk_bf16_f32 v111, v94, v95
    v_mfma_f32_32x32x16_bf16 v[80:95], v[112:115], v[28:31], 0
    v_exp_f32 v64, v64
    v_exp_f32 v65, v65
    v_exp_f32 v66, v66
    v_mfma_f32_32x32x8_bf16 v[80:95], v[124:125], v[54:55], v[80:95]
    v_exp_f32 v67, v67
    v_exp_f32 v68, v68
    v_cvt_pk_bf16_f32 v96, v64, v65
    v_exp_f32 v69, v69
    v_exp_f32 v70, v70
    v_cvt_pk_bf16_f32 v97, v66, v67
    v_exp_f32 v71, v71
    v_cvt_pk_bf16_f32 v98, v68, v69
    v_exp_f32 v72, v72
    v_mfma_f32_32x32x16_bf16 v[168:183], v[130:133], v[104:107], v[168:183]
    v_exp_f32 v73, v73
    v_exp_f32 v74, v74
    v_cvt_pk_bf16_f32 v99, v70, v71
    v_cvt_pk_bf16_f32 v100, v72, v73
    v_mfma_f32_32x32x16_bf16 v[168:183], v[134:137], v[108:111], v[168:183]
    v_exp_f32 v75, v75
    v_exp_f32 v76, v76
    v_exp_f32 v77, v77
    v_cvt_pk_bf16_f32 v101, v74, v75
    ds_write_b128 v13, v[156:159] offset:0
    v_exp_f32 v78, v78
    ds_write_b128 v13, v[160:163] offset:1024
    v_exp_f32 v79, v79
    ds_write_b128 v13, v[164:167] offset:2048
    v_cvt_pk_bf16_f32 v102, v76, v77
    v_cvt_pk_bf16_f32 v103, v78, v79
    v_mfma_f32_32x32x16_bf16 v[64:79], v[112:115], v[32:35], 0
    v_exp_f32 v80, v80
    v_exp_f32 v81, v81
    v_exp_f32 v82, v82
    v_mfma_f32_32x32x8_bf16 v[64:79], v[124:125], v[56:57], v[64:79]
    v_exp_f32 v83, v83
    v_exp_f32 v84, v84
    v_cvt_pk_bf16_f32 v104, v80, v81
    v_exp_f32 v85, v85
    v_exp_f32 v86, v86
    v_cvt_pk_bf16_f32 v105, v82, v83
    v_exp_f32 v87, v87
    v_cvt_pk_bf16_f32 v106, v84, v85
    v_exp_f32 v88, v88
    v_mfma_f32_32x32x16_bf16 v[180:195], v[130:133], v[96:99], v[180:195]
    v_exp_f32 v89, v89
    v_exp_f32 v90, v90
    v_cvt_pk_bf16_f32 v107, v86, v87
    v_cvt_pk_bf16_f32 v108, v88, v89
    v_mfma_f32_32x32x16_bf16 v[180:195], v[134:137], v[100:103], v[180:195]
    v_exp_f32 v91, v91
    v_exp_f32 v92, v92
    v_exp_f32 v93, v93
    v_cvt_pk_bf16_f32 v109, v90, v91
    ds_write_b128 v13, v[168:171] offset:3072
    v_exp_f32 v94, v94
    ds_write_b128 v13, v[172:175] offset:4096
    v_exp_f32 v95, v95
    ds_write_b128 v13, v[176:179] offset:5120
    v_cvt_pk_bf16_f32 v110, v92, v93
    v_cvt_pk_bf16_f32 v111, v94, v95
    v_mfma_f32_32x32x16_bf16 v[80:95], v[112:115], v[36:39], 0
    v_exp_f32 v64, v64
    v_exp_f32 v65, v65
    v_exp_f32 v66, v66
    v_mfma_f32_32x32x8_bf16 v[80:95], v[124:125], v[58:59], v[80:95]
    v_exp_f32 v67, v67
    v_exp_f32 v68, v68
    v_cvt_pk_bf16_f32 v96, v64, v65
    v_exp_f32 v69, v69
    v_exp_f32 v70, v70
    v_cvt_pk_bf16_f32 v97, v66, v67
    v_exp_f32 v71, v71
    v_cvt_pk_bf16_f32 v98, v68, v69
    v_exp_f32 v72, v72
    v_mfma_f32_32x32x16_bf16 v[192:207], v[130:133], v[104:107], v[192:207]
    v_exp_f32 v73, v73
    v_exp_f32 v74, v74
    v_cvt_pk_bf16_f32 v99, v70, v71
    v_cvt_pk_bf16_f32 v100, v72, v73
    v_mfma_f32_32x32x16_bf16 v[192:207], v[134:137], v[108:111], v[192:207]
    v_exp_f32 v75, v75
    v_exp_f32 v76, v76
    v_exp_f32 v77, v77
    v_cvt_pk_bf16_f32 v101, v74, v75
    ds_write_b128 v14, v[180:183] offset:0
    v_exp_f32 v78, v78
    ds_write_b128 v14, v[184:187] offset:1024
    v_exp_f32 v79, v79
    ds_write_b128 v14, v[188:191] offset:2048
    v_cvt_pk_bf16_f32 v102, v76, v77
    v_cvt_pk_bf16_f32 v103, v78, v79
    v_mfma_f32_32x32x16_bf16 v[64:79], v[112:115], v[40:43], 0
    v_exp_f32 v80, v80
    v_exp_f32 v81, v81
    v_exp_f32 v82, v82
    v_mfma_f32_32x32x8_bf16 v[64:79], v[124:125], v[60:61], v[64:79]
    v_exp_f32 v83, v83
    v_exp_f32 v84, v84
    v_cvt_pk_bf16_f32 v104, v80, v81
    v_exp_f32 v85, v85
    v_exp_f32 v86, v86
    v_cvt_pk_bf16_f32 v105, v82, v83
    v_exp_f32 v87, v87
    v_cvt_pk_bf16_f32 v106, v84, v85
    v_exp_f32 v88, v88
    v_mfma_f32_32x32x16_bf16 v[204:219], v[130:133], v[96:99], v[204:219]
    v_exp_f32 v89, v89
    v_exp_f32 v90, v90
    v_cvt_pk_bf16_f32 v107, v86, v87
    v_cvt_pk_bf16_f32 v108, v88, v89
    v_mfma_f32_32x32x16_bf16 v[204:219], v[134:137], v[100:103], v[204:219]
    v_exp_f32 v91, v91
    v_exp_f32 v92, v92
    v_exp_f32 v93, v93
    v_cvt_pk_bf16_f32 v109, v90, v91
    ds_write_b128 v14, v[192:195] offset:3072
    v_exp_f32 v94, v94
    ds_write_b128 v14, v[196:199] offset:4096
    v_exp_f32 v95, v95
    ds_write_b128 v14, v[200:203] offset:5120
    v_cvt_pk_bf16_f32 v110, v92, v93
    v_cvt_pk_bf16_f32 v111, v94, v95
    v_mfma_f32_32x32x16_bf16 v[80:95], v[112:115], v[44:47], 0
    v_exp_f32 v64, v64
    v_exp_f32 v65, v65
    v_exp_f32 v66, v66
    v_mfma_f32_32x32x8_bf16 v[80:95], v[124:125], v[62:63], v[80:95]
    v_exp_f32 v67, v67
    v_exp_f32 v68, v68
    v_cvt_pk_bf16_f32 v96, v64, v65
    v_exp_f32 v69, v69
    v_exp_f32 v70, v70
    v_cvt_pk_bf16_f32 v97, v66, v67
    v_exp_f32 v71, v71
    v_cvt_pk_bf16_f32 v98, v68, v69
    v_exp_f32 v72, v72
    v_mfma_f32_32x32x16_bf16 v[216:231], v[130:133], v[104:107], v[216:231]
    v_exp_f32 v73, v73
    v_exp_f32 v74, v74
    v_cvt_pk_bf16_f32 v99, v70, v71
    v_cvt_pk_bf16_f32 v100, v72, v73
    v_mfma_f32_32x32x16_bf16 v[216:231], v[134:137], v[108:111], v[216:231]
    v_exp_f32 v75, v75
    v_exp_f32 v76, v76
    v_exp_f32 v77, v77
    v_cvt_pk_bf16_f32 v101, v74, v75
    ds_write_b128 v15, v[204:207] offset:0
    v_exp_f32 v78, v78
    ds_write_b128 v15, v[208:211] offset:1024
    v_exp_f32 v79, v79
    ds_write_b128 v15, v[212:215] offset:2048
    v_cvt_pk_bf16_f32 v102, v76, v77
    v_cvt_pk_bf16_f32 v103, v78, v79
    v_exp_f32 v80, v80
    v_exp_f32 v81, v81
    v_exp_f32 v82, v82
    v_exp_f32 v83, v83
    v_exp_f32 v84, v84
    v_cvt_pk_bf16_f32 v104, v80, v81
    v_exp_f32 v85, v85
    v_exp_f32 v86, v86
    v_cvt_pk_bf16_f32 v105, v82, v83
    v_exp_f32 v87, v87
    v_cvt_pk_bf16_f32 v106, v84, v85
    v_exp_f32 v88, v88
    v_mfma_f32_32x32x16_bf16 v[228:243], v[130:133], v[96:99], v[228:243]
    v_exp_f32 v89, v89
    v_exp_f32 v90, v90
    v_cvt_pk_bf16_f32 v107, v86, v87
    v_cvt_pk_bf16_f32 v108, v88, v89
    v_mfma_f32_32x32x16_bf16 v[228:243], v[134:137], v[100:103], v[228:243]
    v_exp_f32 v91, v91
    v_exp_f32 v92, v92
    v_exp_f32 v93, v93
    v_cvt_pk_bf16_f32 v109, v90, v91
    ds_write_b128 v15, v[216:219] offset:3072
    v_exp_f32 v94, v94
    ds_write_b128 v15, v[220:223] offset:4096
    v_exp_f32 v95, v95
    ds_write_b128 v15, v[224:227] offset:5120
    v_cvt_pk_bf16_f32 v110, v92, v93
    v_cvt_pk_bf16_f32 v111, v94, v95
    s_nop 0
    v_mfma_f32_32x32x16_bf16 v[240:255], v[130:133], v[104:107], v[240:255]
    v_mfma_f32_32x32x16_bf16 v[240:255], v[134:137], v[108:111], v[240:255]
    s_waitcnt lgkmcnt(0)
    s_mov_b64 exec, 1
    v_mov_b32 v8, 13
    ds_write_b32 v7, v8
    s_mov_b64 exec, -1
    ds_read_b32 v8, v6
    s_waitcnt lgkmcnt(0)
    v_cmp_gt_u32 vcc, 13, v8
    s_cmp_eq_u64 vcc, 0
    s_cbranch_scc0 L_psl_115
L_pok_113:
    ds_read_b128 v[156:159], v10 offset:0
    ds_read_b128 v[160:163], v10 offset:1024
    ds_read_b128 v[164:167], v10 offset:2048
    ds_read_b128 v[168:171], v10 offset:3072
    ds_read_b128 v[172:175], v10 offset:4096
    ds_read_b128 v[176:179], v10 offset:5120
    ds_read_b128 v[180:183], v10 offset:6144
    ds_read_b128 v[184:187], v10 offset:7168
    ds_read_b128 v[188:191], v10 offset:8192
    ds_read_b128 v[192:195], v10 offset:9216
    ds_read_b128 v[196:199], v10 offset:10240
    ds_read_b128 v[200:203], v10 offset:11264
    ds_read_b128 v[204:207], v10 offset:12288
    ds_read_b128 v[208:211], v10 offset:13312
    ds_read_b128 v[212:215], v10 offset:14336
    ds_read_b128 v[216:219], v10 offset:15360
    ds_read_b128 v[220:223], v10 offset:16384
    ds_read_b128 v[224:227], v10 offset:17408
    s_waitcnt lgkmcnt(12)
    v_pk_add_f32 v[228:229], v[228:229], v[156:157]
    v_pk_add_f32 v[230:231], v[230:231], v[158:159]
    v_pk_add_f32 v[232:233], v[232:233], v[160:161]
    v_pk_add_f32 v[234:235], v[234:235], v[162:163]
    v_pk_add_f32 v[236:237], v[236:237], v[164:165]
    v_pk_add_f32 v[238:239], v[238:239], v[166:167]
    v_pk_add_f32 v[240:241], v[240:241], v[168:169]
    v_pk_add_f32 v[242:243], v[242:243], v[170:171]
    v_pk_add_f32 v[244:245], v[244:245], v[172:173]
    v_pk_add_f32 v[246:247], v[246:247], v[174:175]
    v_pk_add_f32 v[248:249], v[248:249], v[176:177]
    v_pk_add_f32 v[250:251], v[250:251], v[178:179]
    s_waitcnt lgkmcnt(6)
    v_pk_add_f32 v[228:229], v[228:229], v[180:181]
    v_pk_add_f32 v[230:231], v[230:231], v[182:183]
    v_pk_add_f32 v[232:233], v[232:233], v[184:185]
    v_pk_add_f32 v[234:235], v[234:235], v[186:187]
    v_pk_add_f32 v[236:237], v[236:237], v[188:189]
    v_pk_add_f32 v[238:239], v[238:239], v[190:191]
    v_pk_add_f32 v[240:241], v[240:241], v[192:193]
    v_pk_add_f32 v[242:243], v[242:243], v[194:195]
    v_pk_add_f32 v[244:245], v[244:245], v[196:197]
    v_pk_add_f32 v[246:247], v[246:247], v[198:199]
    v_pk_add_f32 v[248:249], v[248:249], v[200:201]
    v_pk_add_f32 v[250:251], v[250:251], v[202:203]
    s_waitcnt lgkmcnt(0)
    v_pk_add_f32 v[228:229], v[228:229], v[204:205]
    v_pk_add_f32 v[230:231], v[230:231], v[206:207]
    v_pk_add_f32 v[232:233], v[232:233], v[208:209]
    v_pk_add_f32 v[234:235], v[234:235], v[210:211]
    v_pk_add_f32 v[236:237], v[236:237], v[212:213]
    v_pk_add_f32 v[238:239], v[238:239], v[214:215]
    v_pk_add_f32 v[240:241], v[240:241], v[216:217]
    v_pk_add_f32 v[242:243], v[242:243], v[218:219]
    v_pk_add_f32 v[244:245], v[244:245], v[220:221]
    v_pk_add_f32 v[246:247], v[246:247], v[222:223]
    v_pk_add_f32 v[248:249], v[248:249], v[224:225]
    v_pk_add_f32 v[250:251], v[250:251], v[226:227]
    v_add_f32_e64 v3, |v228|, |v229|
    v_add_f32_e64 v3, v3, |v230|
    v_add_f32_e64 v3, v3, |v231|
    v_add_f32_e64 v3, v3, |v232|
    v_add_f32_e64 v3, v3, |v233|
    v_add_f32_e64 v3, v3, |v234|
    v_add_f32_e64 v3, v3, |v235|
    v_add_f32_e64 v3, v3, |v236|
    v_add_f32_e64 v3, v3, |v237|
    v_add_f32_e64 v3, v3, |v238|
    v_add_f32_e64 v3, v3, |v239|
    v_add_f32_e64 v3, v3, |v240|
    v_add_f32_e64 v3, v3, |v241|
    v_add_f32_e64 v3, v3, |v242|
    v_add_f32_e64 v3, v3, |v243|
    v_add_f32_e64 v3, v3, |v244|
    v_add_f32_e64 v3, v3, |v245|
    v_add_f32_e64 v3, v3, |v246|
    v_add_f32_e64 v3, v3, |v247|
    v_add_f32_e64 v3, v3, |v248|
    v_add_f32_e64 v3, v3, |v249|
    v_add_f32_e64 v3, v3, |v250|
    v_add_f32_e64 v3, v3, |v251|
    v_cmp_ngt_f32 vcc, s42, v3
    s_cmp_eq_u64 vcc, 0
    s_cbranch_scc0 L_a_fallback
L_a_norm:
    v_mov_b32 v12, 1073741824
    v_cndmask_b32 v12, v12, v2, s[60:61]
    v_mov_b32 v3, v236
    v_mov_b32 v4, v236
    s_nop 1
    v_permlane32_swap_b32 v3, v4
    s_nop 1
    v_rcp_f32 v4, v4
    s_nop 0
    v_mul_f32 v228, v228, v4
    v_mul_f32 v229, v229, v4
    v_mul_f32 v230, v230, v4
    v_mul_f32 v231, v231, v4
    v_mul_f32 v232, v232, v4
    v_mul_f32 v233, v233, v4
    v_mul_f32 v234, v234, v4
    v_mul_f32 v235, v235, v4
    v_mul_f32 v236, v236, v4
    v_mul_f32 v237, v237, v4
    v_mul_f32 v238, v238, v4
    v_mul_f32 v239, v239, v4
    v_cvt_pk_bf16_f32 v64, v228, v229
    v_cvt_pk_bf16_f32 v65, v230, v231
    v_cvt_pk_bf16_f32 v66, v232, v233
    v_cvt_pk_bf16_f32 v67, v234, v235
    v_cvt_pk_bf16_f32 v68, v236, v237
    v_cvt_pk_bf16_f32 v69, v238, v239
    buffer_store_dwordx4 v[64:67], v2, s[20:23], s38 offen sc1
    buffer_store_dwordx2 v[68:69], v12, s[20:23], s39 offen sc1
    v_mov_b32 v3, v248
    v_mov_b32 v4, v248
    s_nop 1
    v_permlane32_swap_b32 v3, v4
    s_nop 1
    v_rcp_f32 v4, v4
    s_nop 0
    v_mul_f32 v240, v240, v4
    v_mul_f32 v241, v241, v4
    v_mul_f32 v242, v242, v4
    v_mul_f32 v243, v243, v4
    v_mul_f32 v244, v244, v4
    v_mul_f32 v245, v245, v4
    v_mul_f32 v246, v246, v4
    v_mul_f32 v247, v247, v4
    v_mul_f32 v248, v248, v4
    v_mul_f32 v249, v249, v4
    v_mul_f32 v250, v250, v4
    v_mul_f32 v251, v251, v4
    v_cvt_pk_bf16_f32 v80, v240, v241
    v_cvt_pk_bf16_f32 v81, v242, v243
    v_cvt_pk_bf16_f32 v82, v244, v245
    v_cvt_pk_bf16_f32 v83, v246, v247
    v_cvt_pk_bf16_f32 v84, v248, v249
    v_cvt_pk_bf16_f32 v85, v250, v251
    buffer_store_dwordx4 v[80:83], v2, s[20:23], s40 offen sc1
    buffer_store_dwordx2 v[84:85], v12, s[20:23], s41 offen sc1
    s_endpgm
L_a_fallback:
    s_waitcnt vmcnt(0) lgkmcnt(0)
    v_mov_b32 v13, 0xff800000
    v_cndmask_b32 v60, v5, v60, s[60:61]
    v_mov_b32 v14, 0xff800000
    v_cndmask_b32 v62, v5, v62, s[60:61]
    s_mov_b32 s43, 0
L_a_fb1:
    buffer_load_dwordx4 v[112:115], v2, s[16:19], s43 offen sc1
    buffer_load_dwordx2 v[124:125], v9, s[16:19], s43 offen offset:1024 sc1
    s_waitcnt vmcnt(0)
    v_mfma_f32_32x32x16_bf16 v[64:79], v[112:115], v[40:43], 0
    v_mfma_f32_32x32x8_bf16 v[64:79], v[124:125], v[60:61], v[64:79]
    v_mfma_f32_32x32x16_bf16 v[80:95], v[112:115], v[44:47], 0
    v_mfma_f32_32x32x8_bf16 v[80:95], v[124:125], v[62:63], v[80:95]
    s_nop 7
    s_nop 7
    v_max3_f32 v13, v13, v64, v65
    v_max3_f32 v13, v13, v66, v67
    v_max3_f32 v13, v13, v68, v69
    v_max3_f32 v13, v13, v70, v71
    v_max3_f32 v13, v13, v72, v73
    v_max3_f32 v13, v13, v74, v75
    v_max3_f32 v13, v13, v76, v77
    v_max3_f32 v13, v13, v78, v79
    v_max3_f32 v14, v14, v80, v81
    v_max3_f32 v14, v14, v82, v83
    v_max3_f32 v14, v14, v84, v85
    v_max3_f32 v14, v14, v86, v87
    v_max3_f32 v14, v14, v88, v89
    v_max3_f32 v14, v14, v90, v91
    v_max3_f32 v14, v14, v92, v93
    v_max3_f32 v14, v14, v94, v95
    s_add_u32 s43, s43, 3072
    s_cmp_lt_u32 s43, 196608
    s_cbranch_scc1 L_a_fb1
    v_mov_b32 v4, v13
    s_nop 1
    v_permlane32_swap_b32 v13, v4
    s_nop 1
    v_max_f32 v13, v13, v4
    v_sub_f32 v188, 0, v13
    v_mov_b32 v156, 0
    v_sub_f32 v189, 0, v13
    v_mov_b32 v157, 0
    v_sub_f32 v190, 0, v13
    v_mov_b32 v158, 0
    v_sub_f32 v191, 0, v13
    v_mov_b32 v159, 0
    v_sub_f32 v192, 0, v13
    v_mov_b32 v160, 0
    v_sub_f32 v193, 0, v13
    v_mov_b32 v161, 0
    v_sub_f32 v194, 0, v13
    v_mov_b32 v162, 0
    v_sub_f32 v195, 0, v13
    v_mov_b32 v163, 0
    v_sub_f32 v196, 0, v13
    v_mov_b32 v164, 0
    v_sub_f32 v197, 0, v13
    v_mov_b32 v165, 0
    v_sub_f32 v198, 0, v13
    v_mov_b32 v166, 0
    v_sub_f32 v199, 0, v13
    v_mov_b32 v167, 0
    v_sub_f32 v200, 0, v13
    v_mov_b32 v168, 0
    v_sub_f32 v201, 0, v13
    v_mov_b32 v169, 0
    v_sub_f32 v202, 0, v13
    v_mov_b32 v170, 0
    v_sub_f32 v203, 0, v13
    v_mov_b32 v171, 0
    v_mov_b32 v4, v14
    s_nop 1
    v_permlane32_swap_b32 v14, v4
    s_nop 1
    v_max_f32 v14, v14, v4
    v_sub_f32 v204, 0, v14
    v_mov_b32 v172, 0
    v_sub_f32 v205, 0, v14
    v_mov_b32 v173, 0
    v_sub_f32 v206, 0, v14
    v_mov_b32 v174, 0
    v_sub_f32 v207, 0, v14
    v_mov_b32 v175, 0
    v_sub_f32 v208, 0, v14
    v_mov_b32 v176, 0
    v_sub_f32 v209, 0, v14
    v_mov_b32 v177, 0
    v_sub_f32 v210, 0, v14
    v_mov_b32 v178, 0
    v_sub_f32 v211, 0, v14
    v_mov_b32 v179, 0
    v_sub_f32 v212, 0, v14
    v_mov_b32 v180, 0
    v_sub_f32 v213, 0, v14
    v_mov_b32 v181, 0
    v_sub_f32 v214, 0, v14
    v_mov_b32 v182, 0
    v_sub_f32 v215, 0, v14
    v_mov_b32 v183, 0
    v_sub_f32 v216, 0, v14
    v_mov_b32 v184, 0
    v_sub_f32 v217, 0, v14
    v_mov_b32 v185, 0
    v_sub_f32 v218, 0, v14
    v_mov_b32 v186, 0
    v_sub_f32 v219, 0, v14
    v_mov_b32 v187, 0
    s_mov_b32 s43, 0
L_a_fb2:
    buffer_load_dwordx4 v[112:115], v2, s[16:19], s43 offen sc1
    buffer_load_dwordx2 v[124:125], v9, s[16:19], s43 offen offset:1024 sc1
    buffer_load_dwordx4 v[130:133], v11, s[16:19], s43 offen offset:1536 sc1
    buffer_load_dwordx4 v[134:137], v11, s[16:19], s43 offen offset:2304 sc1
    s_waitcnt vmcnt(0)
    v_mfma_f32_32x32x16_bf16 v[64:79], v[112:115], v[40:43], v[188:203]
    v_mfma_f32_32x32x8_bf16 v[64:79], v[124:125], v[60:61], v[64:79]
    v_mfma_f32_32x32x16_bf16 v[80:95], v[112:115], v[44:47], v[204:219]
    v_mfma_f32_32x32x8_bf16 v[80:95], v[124:125], v[62:63], v[80:95]
    s_nop 7
    s_nop 7
    v_exp_f32 v64, v64
    v_exp_f32 v65, v65
    v_exp_f32 v66, v66
    v_exp_f32 v67, v67
    v_exp_f32 v68, v68
    v_exp_f32 v69, v69
    v_exp_f32 v70, v70
    v_exp_f32 v71, v71
    v_exp_f32 v72, v72
    v_exp_f32 v73, v73
    v_exp_f32 v74, v74
    v_exp_f32 v75, v75
    v_exp_f32 v76, v76
    v_exp_f32 v77, v77
    v_exp_f32 v78, v78
    v_exp_f32 v79, v79
    s_nop 0
    v_cvt_pk_bf16_f32 v96, v64, v65
    v_cvt_pk_bf16_f32 v97, v66, v67
    v_cvt_pk_bf16_f32 v98, v68, v69
    v_cvt_pk_bf16_f32 v99, v70, v71
    v_cvt_pk_bf16_f32 v100, v72, v73
    v_cvt_pk_bf16_f32 v101, v74, v75
    v_cvt_pk_bf16_f32 v102, v76, v77
    v_cvt_pk_bf16_f32 v103, v78, v79
    s_nop 1
    v_mfma_f32_32x32x16_bf16 v[156:171], v[130:133], v[96:99], v[156:171]
    v_mfma_f32_32x32x16_bf16 v[156:171], v[134:137], v[100:103], v[156:171]
    v_exp_f32 v80, v80
    v_exp_f32 v81, v81
    v_exp_f32 v82, v82
    v_exp_f32 v83, v83
    v_exp_f32 v84, v84
    v_exp_f32 v85, v85
    v_exp_f32 v86, v86
    v_exp_f32 v87, v87
    v_exp_f32 v88, v88
    v_exp_f32 v89, v89
    v_exp_f32 v90, v90
    v_exp_f32 v91, v91
    v_exp_f32 v92, v92
    v_exp_f32 v93, v93
    v_exp_f32 v94, v94
    v_exp_f32 v95, v95
    s_nop 0
    v_cvt_pk_bf16_f32 v104, v80, v81
    v_cvt_pk_bf16_f32 v105, v82, v83
    v_cvt_pk_bf16_f32 v106, v84, v85
    v_cvt_pk_bf16_f32 v107, v86, v87
    v_cvt_pk_bf16_f32 v108, v88, v89
    v_cvt_pk_bf16_f32 v109, v90, v91
    v_cvt_pk_bf16_f32 v110, v92, v93
    v_cvt_pk_bf16_f32 v111, v94, v95
    s_nop 1
    v_mfma_f32_32x32x16_bf16 v[172:187], v[130:133], v[104:107], v[172:187]
    v_mfma_f32_32x32x16_bf16 v[172:187], v[134:137], v[108:111], v[172:187]
    s_add_u32 s43, s43, 3072
    s_cmp_lt_u32 s43, 196608
    s_cbranch_scc1 L_a_fb2
    s_nop 7
    s_nop 7
    v_mov_b32 v228, v156
    v_mov_b32 v229, v157
    v_mov_b32 v230, v158
    v_mov_b32 v231, v159
    v_mov_b32 v232, v160
    v_mov_b32 v233, v161
    v_mov_b32 v234, v162
    v_mov_b32 v235, v163
    v_mov_b32 v236, v164
    v_mov_b32 v237, v165
    v_mov_b32 v238, v166
    v_mov_b32 v239, v167
    v_mov_b32 v240, v172
    v_mov_b32 v241, v173
    v_mov_b32 v242, v174
    v_mov_b32 v243, v175
    v_mov_b32 v244, v176
    v_mov_b32 v245, v177
    v_mov_b32 v246, v178
    v_mov_b32 v247, v179
    v_mov_b32 v248, v180
    v_mov_b32 v249, v181
    v_mov_b32 v250, v182
    v_mov_b32 v251, v183
    s_branch L_a_norm
L_psl_73:
    s_mov_b32 s63, 262144
L_plp_72:
    s_sleep 1
    ds_read_b32 v4, v6
    s_waitcnt lgkmcnt(0)
    s_sub_u32 s63, s63, 1
    s_cbranch_scc1 L_pok_71
    v_cmp_gt_u32 vcc, 3, v4
    s_cmp_eq_u64 vcc, 0
    s_cbranch_scc0 L_plp_72
    s_branch L_pok_71
L_psl_76:
    s_mov_b32 s63, 262144
L_plp_75:
    s_sleep 1
    ds_read_b32 v4, v224
    s_waitcnt lgkmcnt(0)
    s_sub_u32 s63, s63, 1
    s_cbranch_scc1 L_pok_74
    v_cmp_gt_u32 vcc, 1, v4
    s_cmp_eq_u64 vcc, 0
    s_cbranch_scc0 L_plp_75
    s_branch L_pok_74
L_psl_79:
    s_mov_b32 s63, 262144
L_plp_78:
    s_sleep 1
    ds_read_b32 v4, v14
    s_waitcnt lgkmcnt(0)
    s_sub_u32 s63, s63, 1
    s_cbranch_scc1 L_pok_77
    v_cmp_gt_u32 vcc, 3, v4
    s_cmp_eq_u64 vcc, 0
    s_cbranch_scc0 L_plp_78
    s_branch L_pok_77
L_psl_82:
    s_mov_b32 s63, 262144
L_plp_81:
    s_sleep 1
    ds_read_b32 v4, v14
    s_waitcnt lgkmcnt(0)
    s_sub_u32 s63, s63, 1
    s_cbranch_scc1 L_pok_80
    v_cmp_gt_u32 vcc, 4, v4
    s_cmp_eq_u64 vcc, 0
    s_cbranch_scc0 L_plp_81
    s_branch L_pok_80
L_psl_87:
    s_mov_b32 s63, 262144
L_plp_86:
    s_sleep 1
    ds_read_b32 v4, v6
    s_waitcnt lgkmcnt(0)
    s_sub_u32 s63, s63, 1
    s_cbranch_scc1 L_pok_85
    v_cmp_gt_u32 vcc, 8, v4
    s_cmp_eq_u64 vcc, 0
    s_cbranch_scc0 L_plp_86
    s_branch L_pok_85
L_psl_90:
    s_mov_b32 s63, 262144
L_plp_89:
    s_sleep 1
    ds_read_b32 v3, v6
    s_waitcnt lgkmcnt(0)
    s_sub_u32 s63, s63, 1
    s_cbranch_scc1 L_pok_88
    v_cmp_gt_u32 vcc, 9, v3
    s_cmp_eq_u64 vcc, 0
    s_cbranch_scc0 L_plp_89
    s_branch L_pok_88
L_psl_95:
    s_mov_b32 s63, 262144
L_plp_94:
    s_sleep 1
    ds_read_b32 v8, v6
    s_waitcnt lgkmcnt(0)
    s_sub_u32 s63, s63, 1
    s_cbranch_scc1 L_pok_93
    v_cmp_gt_u32 vcc, 11, v8
    s_cmp_eq_u64 vcc, 0
    s_cbranch_scc0 L_plp_94
    s_branch L_pok_93
L_cw_96:
    v_mov_b32 v120, -1
    v_mov_b32 v121, -1
    v_mov_b32 v122, -1
    v_mov_b32 v123, -1
    buffer_store_dwordx4 v[120:123], v2, s[20:23], s38 offen sc1
    buffer_store_dwordx4 v[120:123], v2, s[20:23], s40 offen sc1
    s_mov_b64 exec, s[60:61]
    buffer_store_dwordx2 v[120:121], v2, s[20:23], s39 offen sc1
    buffer_store_dwordx2 v[120:121], v2, s[20:23], s41 offen sc1
    s_mov_b64 exec, -1
    s_branch L_cr_97
L_cw_98:
    buffer_load_dword v155, v154, s[92:95], s35 offen
    s_add_u32 s35, s35, 655360
    s_branch L_cr_99
L_cw_100:
    s_waitcnt vmcnt(8)
    s_mov_b64 exec, 1
    v_mov_b32 v3, 12
    ds_write_b32 v7, v3
    s_mov_b64 exec, -1
    s_branch L_cr_101
L_cw_102:
    buffer_load_dword v155, v154, s[92:95], s35 offen
    s_add_u32 s35, s35, 655360
    s_branch L_cr_103
L_cw_104:
    buffer_load_dword v155, v154, s[96:99], s33 offen
    s_add_u32 s33, s33, 409600
    s_branch L_cr_105
L_cw_106:
    buffer_load_dword v155, v154, s[92:95], s35 offen
    s_add_u32 s35, s35, 655360
    s_branch L_cr_107
L_cw_108:
    buffer_load_dword v155, v154, s[96:99], s33 offen
    s_add_u32 s33, s33, 409600
    s_branch L_cr_109
L_psl_112:
    s_mov_b32 s63, 262144
L_plp_111:
    s_sleep 1
    ds_read_b32 v8, v12
    s_waitcnt lgkmcnt(0)
    s_sub_u32 s63, s63, 1
    s_cbranch_scc1 L_pok_110
    v_cmp_gt_u32 vcc, 5, v8
    s_cmp_eq_u64 vcc, 0
    s_cbranch_scc0 L_plp_111
    s_branch L_pok_110
L_psl_115:
    s_mov_b32 s63, 262144
L_plp_114:
    s_sleep 1
    ds_read_b32 v8, v6
    s_waitcnt lgkmcnt(0)
    s_sub_u32 s63, s63, 1
    s_cbranch_scc1 L_pok_113
    v_cmp_gt_u32 vcc, 13, v8
    s_cmp_eq_u64 vcc, 0
    s_cbranch_scc0 L_plp_114
    s_branch L_pok_113
L_end:
    s_endpgm
.section .rodata,"a"
.p2align 6
.amdhsa_kernel parallel_sum__grouped_kv_mqa__glu_gated_bilinear__prompt_kernel
  .amdhsa_next_free_vgpr 256
  .amdhsa_next_free_sgpr 102
  .amdhsa_accum_offset 256
  .amdhsa_group_segment_fixed_size 0
  .amdhsa_kernarg_size 96
  .amdhsa_user_sgpr_count 2
  .amdhsa_user_sgpr_kernarg_segment_ptr 1
  .amdhsa_system_sgpr_workgroup_id_x 1
.end_amdhsa_kernel
```
